```python
import torch

def _softmax(x, axis=-1):
    return torch.softmax(x, dim=axis)
def _gelu(x):
    return torch.nn.functional.gelu(x, approximate="tanh")
def _silu(x):
    return torch.nn.functional.silu(x)
def _sigmoid(x):
    return torch.sigmoid(x)
def _layernorm(x, axis=-1, eps=1e-5):
    m = x.mean(dim=axis, keepdim=True)
    v = x.var(dim=axis, keepdim=True, unbiased=False)
    return (x - m) / torch.sqrt(v + eps)
def _scatter_add(tgt, idx, src, axis=0):
    return tgt.clone().index_add_(axis, idx, src)
def _segment_sum(src, seg, n):
    out = torch.zeros((n,) + src.shape[1:], dtype=src.dtype)
    return out.index_add_(0, seg, src)
def _pad(x, pw):
    flat = tuple(v for pair in reversed(pw) for v in pair)
    return torch.nn.functional.pad(x, flat)

kernel_name = 'parallel_sum__gqa_block_cached__glu_gated_bilinear__decode'

def setup_inputs():

    _w = (lambda a: (lambda t: t.to(torch.bfloat16) if t.is_floating_point() else t)(torch.as_tensor(a)))
    def _A_setup():
        B, Sq, D = 8, 1, 512
        Hq, Hkv, Sk, Dh = 32, 8, 8192, 128
        assert Hq % Hkv == 0, (Hq, Hkv)
        return {
            "x": _w((lambda *s: torch.randn(*s, dtype=torch.bfloat16) * 0.05)(B, Sq, D)),
            "k_cache": _w((lambda *s: torch.randn(*s, dtype=torch.bfloat16) * 1.6)(B, Hkv, Sk, Dh)),
            "v_cache": _w((lambda *s: torch.randn(*s, dtype=torch.bfloat16) * 0.8)(B, Hkv, Sk, Dh)),
            "wq": _w((lambda *s: torch.randn(*s, dtype=torch.bfloat16) * 1.6)(D, Hq * Dh) * (D ** -0.5)),
            "wo": _w((lambda *s: torch.randn(*s, dtype=torch.bfloat16) * 0.8)(Hq * Dh, D) * ((Hq * Dh) ** -0.5)),
        }
    _A_in = _A_setup()

    def _B_setup():
        B, S, D, F = 8, 1, 512, 1792
        return {
            "x": _w((lambda *s: torch.randn(*s, dtype=torch.bfloat16) * 0.05)(B, S, D)),
            "w_gate": _w((lambda *s: torch.randn(*s, dtype=torch.bfloat16) * 0.4)(D, F) * (D ** -0.5)),
            "w_up": _w((lambda *s: torch.randn(*s, dtype=torch.bfloat16) * 0.4)(D, F) * (D ** -0.5)),
            "w_down": _w((lambda *s: torch.randn(*s, dtype=torch.bfloat16) * 0.4)(F, D) * (F ** -0.5)),
        }
    _B_in = _B_setup()

    return {
        "A_x": _A_in["x"],
        "A_k_cache": _A_in["k_cache"],
        "A_v_cache": _A_in["v_cache"],
        "A_wq": _A_in["wq"],
        "A_wo": _A_in["wo"],
        "B_x": _B_in["x"],
        "B_w_gate": _B_in["w_gate"],
        "B_w_up": _B_in["w_up"],
        "B_w_down": _B_in["w_down"],
    }

def reference(A_x, A_k_cache, A_v_cache, A_wq, A_wo, B_x, B_w_gate, B_w_up, B_w_down):
    def _A_ref(x, k_cache, v_cache, wq, wo):
        B, Sq, D = x.shape
        Hq, Dh = 32, 128
        Hkv = k_cache.shape[1]
        rep = Hq // Hkv
        q = (lambda x, *d: x.permute(*d))((x @ wq).reshape(B, Sq, Hq, Dh), 0, 2, 1, 3)
        k = (lambda x, n, axis: torch.repeat_interleave(x, n, dim=axis))(k_cache, rep, axis=1)
        v = (lambda x, n, axis: torch.repeat_interleave(x, n, dim=axis))(v_cache, rep, axis=1)
        scores = torch.einsum("bhqd,bhkd->bhqk", q, k) * (Dh ** -0.5)
        p = _softmax(scores, axis=-1)
        o = torch.einsum("bhqk,bhkd->bhqd", p, v)
        return (lambda x, *d: x.permute(*d))(o, 0, 2, 1, 3).reshape(B, Sq, Hq * Dh) @ wo

    def _B_ref(x, w_gate, w_up, w_down):
        g = torch.einsum("bsd,df->bsf", x, w_gate)
        u = torch.einsum("bsd,df->bsf", x, w_up)
        h = g * u
        return torch.einsum("bsf,fd->bsd", h, w_down)

    x = A_x
    xn = _layernorm(x, axis=-1)
    return x + _A_ref(xn, A_k_cache, A_v_cache, A_wq, A_wo) + _B_ref(xn, B_w_gate, B_w_up, B_w_down)
```

```asm
; @launch grid=(256,1,1) block=(512,1,1) lds=163840
.amdgcn_target "amdgcn-amd-amdhsa--gfx950"
.text
.globl parallel_sum__gqa_block_cached__glu_gated_bilinear__decode_kernel
.p2align 8
.type parallel_sum__gqa_block_cached__glu_gated_bilinear__decode_kernel,@function
parallel_sum__gqa_block_cached__glu_gated_bilinear__decode_kernel:
    s_load_dwordx2 s[32:33], s[0:1], 8
    v_lshrrev_b32 v9, 6, v0
    s_lshr_b32 s7, s2, 6
    v_readfirstlane_b32 s3, v9
    s_cmp_ge_u32 s7, 4
    s_cbranch_scc1 L_done
    s_and_b32 s6, s7, 2
    s_add_u32 s6, s6, s7
    s_add_u32 s6, s6, s2
    s_and_b32 s6, s6, 7
    s_and_b32 s50, s2, 56
    s_or_b32 s6, s6, s50
    s_cmp_ge_u32 s3, 4
    s_cbranch_scc1 L_service
    v_and_b32 v2, 1, v0
    v_and_b32 v9, 48, v0
    v_lshlrev_b32 v2, 4, v2
    v_lshl_or_b32 v15, v9, 1, v2
    s_lshl_b32 s62, s6, 21
    s_lshl_b32 s50, s7, 2
    s_add_u32 s50, s50, s3
    s_lshl_b32 s50, s50, 12
    s_add_u32 s52, s50, s62
    v_and_b32 v9, 12, v0
    v_lshl_or_b32 v2, v9, 6, v15
    v_and_b32 v9, 2, v0
    v_lshl_or_b32 v2, v9, 9, v2
    s_brev_b32 s34, 16
    s_mov_b32 s35, 0x20000
    s_waitcnt lgkmcnt(0)
    buffer_load_dwordx4 v[96:99], v2, s[32:35], s52 offen offset:0 nt
    buffer_load_dwordx4 v[100:103], v2, s[32:35], s52 offen offset:128 nt
    buffer_load_dwordx4 v[104:107], v2, s[32:35], s52 offen offset:2048 nt
    buffer_load_dwordx4 v[108:111], v2, s[32:35], s52 offen offset:2176 nt
    s_add_u32 s52, s52, 65536
    buffer_load_dwordx4 v[112:115], v2, s[32:35], s52 offen offset:0 nt
    buffer_load_dwordx4 v[116:119], v2, s[32:35], s52 offen offset:128 nt
    buffer_load_dwordx4 v[120:123], v2, s[32:35], s52 offen offset:2048 nt
    buffer_load_dwordx4 v[124:127], v2, s[32:35], s52 offen offset:2176 nt
    s_add_u32 s50, s50, s62
    s_mul_i32 s63, s3, 20480
    s_load_dwordx16 s[8:23], s[0:1], 0
    s_load_dwordx8 s[24:31], s[0:1], 64
    s_xor_b32 s3, s3, 4
    v_and_b32 v1, 63, v0
    v_mov_b32 v10, 8448
    v_mov_b32 v16, 0
    s_lshr_b32 s5, s2, 3
    s_and_b32 s4, s5, 7
    s_and_b32 s5, s5, 24
    s_and_b32 s51, s2, 7
    s_or_b32 s5, s5, s51
    v_lshrrev_b32 v12, 4, v1
    v_and_b32 v13, 15, v1
    v_lshlrev_b32 v14, 4, v1
    s_mov_b32 s58, 1048576
    s_waitcnt lgkmcnt(0)
    s_load_dword s48, s[30:31], 0
    s_mov_b32 s77, 3641344
    s_load_dword s76, s[30:31], s77
    s_mov_b32 s36, s12
    s_and_b32 s37, s13, 0xffff
    s_mov_b32 s38, 0x8000000
    s_mov_b32 s39, 0x20000
    s_mov_b32 s40, s30
    s_and_b32 s41, s31, 0xffff
    s_mov_b32 s42, 0x379100
    s_mov_b32 s43, 0x20000
    s_lshl_b32 s51, s6, 8
    s_add_u32 s64, s30, s51
    s_addc_u32 s65, s31, 0
    s_lshl_b32 s51, s3, 12
    s_add_u32 s62, s62, s51
    s_add_u32 s62, s62, 1802240
    v_mov_b32 v88, 8480
    v_mov_b32 v90, 1
    s_add_u32 s63, s63, 81920
    v_lshrrev_b32 v9, 2, v13
    v_lshlrev_b32 v9, 8, v9
    v_add_u32 v3, v15, v9
    s_mov_b32 s54, 0xcccccccc
    s_mov_b32 s55, 0xcccccccc
    s_mov_b32 s56, 0xaaaaaaaa
    s_mov_b32 s57, 0xaaaaaaaa
    s_mov_b32 s60, 0xffff0000
    s_mov_b32 s61, 0x3db504f3
    s_mov_b32 s53, 0x3fb8aa3b
    v_mov_b32 v6, 0xff800000
    v_mov_b32 v7, 0
    v_mov_b32 v9, 0xffff
    v_mov_b32 v11, s60
    v_cndmask_b32 v9, v9, v11, s[56:57]
    v_cndmask_b32 v4, v9, 0, s[54:55]
    v_cndmask_b32 v5, 0, v9, s[54:55]
    v_add_u32 v15, s63, v14
    s_lshl_b32 s78, s5, 5
    s_lshl_b32 s51, s3, 3
    s_add_u32 s78, s78, s51
    s_sub_u32 s78, s78, 32
    s_lshl_b32 s78, s78, 9
    s_add_u32 s78, s78, 1048576
    v_lshrrev_b32 v9, 5, v1
    v_and_b32 v11, 31, v1
    v_lshlrev_b32 v84, 11, v9
    v_lshl_add_u32 v84, v11, 4, v84
    v_mul_u32_u24 v86, 272, v9
    v_lshl_add_u32 v86, v11, 3, v86
    s_add_u32 s51, s51, 9696
    v_lshl_add_u32 v87, v1, 3, s51
    s_mul_i32 s51, s3, 544
    s_add_u32 s51, s51, 7680
    v_add_u32 v86, s51, v86
    s_barrier
    s_waitcnt vmcnt(5)
    s_add_u32 s52, s52, 65536
    buffer_load_dwordx4 v[128:131], v2, s[32:35], s52 offen offset:0 nt
    s_waitcnt vmcnt(5)
    buffer_load_dwordx4 v[132:135], v2, s[32:35], s52 offen offset:128 nt
    s_waitcnt vmcnt(5)
    buffer_load_dwordx4 v[136:139], v2, s[32:35], s52 offen offset:2048 nt
    s_waitcnt vmcnt(5)
    buffer_load_dwordx4 v[140:143], v2, s[32:35], s52 offen offset:2176 nt
    s_waitcnt vmcnt(5)
    s_add_u32 s52, s52, 65536
    buffer_load_dwordx4 v[144:147], v2, s[32:35], s52 offen offset:0 nt
    s_waitcnt vmcnt(5)
    buffer_load_dwordx4 v[148:151], v2, s[32:35], s52 offen offset:128 nt
    s_waitcnt vmcnt(5)
    buffer_load_dwordx4 v[152:155], v2, s[32:35], s52 offen offset:2048 nt
    s_waitcnt vmcnt(5)
    buffer_load_dwordx4 v[156:159], v2, s[32:35], s52 offen offset:2176 nt
    s_waitcnt vmcnt(5)
    s_add_u32 s52, s52, 65536
    buffer_load_dwordx4 v[160:163], v2, s[32:35], s52 offen offset:0 nt
    s_waitcnt vmcnt(5)
    buffer_load_dwordx4 v[164:167], v2, s[32:35], s52 offen offset:128 nt
    s_waitcnt vmcnt(5)
    buffer_load_dwordx4 v[168:171], v2, s[32:35], s52 offen offset:2048 nt
    s_waitcnt vmcnt(5)
    buffer_load_dwordx4 v[172:175], v2, s[32:35], s52 offen offset:2176 nt
    s_waitcnt vmcnt(5)
    s_add_u32 s52, s52, 65536
    buffer_load_dwordx4 v[176:179], v2, s[32:35], s52 offen offset:0 nt
    s_waitcnt vmcnt(5)
    buffer_load_dwordx4 v[180:183], v2, s[32:35], s52 offen offset:128 nt
    s_waitcnt vmcnt(5)
    buffer_load_dwordx4 v[184:187], v2, s[32:35], s52 offen offset:2048 nt
    s_waitcnt vmcnt(5)
    buffer_load_dwordx4 v[188:191], v2, s[32:35], s52 offen offset:2176 nt
    s_waitcnt vmcnt(5)
    s_add_u32 s52, s52, 65536
    buffer_load_dwordx4 v[192:195], v2, s[32:35], s52 offen offset:0 nt
    s_waitcnt vmcnt(5)
    buffer_load_dwordx4 v[196:199], v2, s[32:35], s52 offen offset:128 nt
    s_waitcnt vmcnt(5)
    buffer_load_dwordx4 v[200:203], v2, s[32:35], s52 offen offset:2048 nt
    s_waitcnt vmcnt(5)
    buffer_load_dwordx4 v[204:207], v2, s[32:35], s52 offen offset:2176 nt
    s_waitcnt vmcnt(5)
    s_add_u32 s52, s52, 65536
    buffer_load_dwordx4 v[208:211], v2, s[32:35], s52 offen offset:0 nt
    s_waitcnt vmcnt(5)
    buffer_load_dwordx4 v[212:215], v2, s[32:35], s52 offen offset:128 nt
    s_waitcnt vmcnt(5)
    buffer_load_dwordx4 v[216:219], v2, s[32:35], s52 offen offset:2048 nt
    s_waitcnt vmcnt(5)
    buffer_load_dwordx4 v[220:223], v2, s[32:35], s52 offen offset:2176 nt
    s_waitcnt vmcnt(5)
    s_add_u32 s52, s52, 65536
    buffer_load_dwordx4 v[224:227], v2, s[32:35], s52 offen offset:0 nt
    s_waitcnt vmcnt(5)
    buffer_load_dwordx4 v[228:231], v2, s[32:35], s52 offen offset:128 nt
    s_waitcnt vmcnt(5)
    buffer_load_dwordx4 v[232:235], v2, s[32:35], s52 offen offset:2048 nt
    s_waitcnt vmcnt(5)
    buffer_load_dwordx4 v[236:239], v2, s[32:35], s52 offen offset:2176 nt
    s_waitcnt vmcnt(5)
    s_add_u32 s52, s52, 65536
    buffer_load_dwordx4 v[240:243], v2, s[32:35], s52 offen offset:0 nt
    s_waitcnt vmcnt(5)
    buffer_load_dwordx4 v[244:247], v2, s[32:35], s52 offen offset:128 nt
    s_waitcnt vmcnt(5)
    buffer_load_dwordx4 v[248:251], v2, s[32:35], s52 offen offset:2048 nt
    s_waitcnt vmcnt(5)
    buffer_load_dwordx4 v[252:255], v2, s[32:35], s52 offen offset:2176 nt
    s_waitcnt vmcnt(5)
    s_add_u32 s52, s52, 65536
    s_add_u32 m0, s63, 0
    s_nop 0
    buffer_load_dwordx4 v2, s[32:35], s52 offen offset:0 nt lds
    s_waitcnt vmcnt(5)
    s_add_u32 m0, s63, 896
    s_nop 0
    buffer_load_dwordx4 v2, s[32:35], s52 offen offset:128 nt lds
    s_waitcnt vmcnt(5)
    s_add_u32 m0, s63, 0
    s_nop 0
    buffer_load_dwordx4 v2, s[32:35], s52 offen offset:2048 nt lds
    s_mov_b64 exec, 1
    ds_add_u32 v10, v90 offset:8
    s_mov_b64 exec, -1
    s_waitcnt vmcnt(5)
    s_add_u32 m0, s63, 896
    s_nop 0
    buffer_load_dwordx4 v2, s[32:35], s52 offen offset:2176 nt lds
    s_waitcnt vmcnt(5)
    s_add_u32 s52, s52, 65536
    s_add_u32 m0, s63, 4096
    s_nop 0
    buffer_load_dwordx4 v2, s[32:35], s52 offen offset:0 nt lds
    s_waitcnt vmcnt(5)
    s_add_u32 m0, s63, 4992
    s_nop 0
    buffer_load_dwordx4 v2, s[32:35], s52 offen offset:128 nt lds
    s_waitcnt vmcnt(5)
    s_add_u32 m0, s63, 4096
    s_nop 0
    buffer_load_dwordx4 v2, s[32:35], s52 offen offset:2048 nt lds
    s_waitcnt vmcnt(5)
    s_add_u32 m0, s63, 4992
    s_nop 0
    buffer_load_dwordx4 v2, s[32:35], s52 offen offset:2176 nt lds
    s_waitcnt vmcnt(5)
    s_add_u32 s52, s52, 65536
    s_add_u32 m0, s63, 8192
    s_nop 0
    buffer_load_dwordx4 v2, s[32:35], s52 offen offset:0 nt lds
    s_waitcnt vmcnt(5)
    s_add_u32 m0, s63, 9088
    s_nop 0
    buffer_load_dwordx4 v2, s[32:35], s52 offen offset:128 nt lds
    s_waitcnt vmcnt(5)
    s_add_u32 m0, s63, 8192
    s_nop 0
    buffer_load_dwordx4 v2, s[32:35], s52 offen offset:2048 nt lds
    s_waitcnt vmcnt(5)
    s_add_u32 m0, s63, 9088
    s_nop 0
    buffer_load_dwordx4 v2, s[32:35], s52 offen offset:2176 nt lds
    s_waitcnt vmcnt(5)
    s_add_u32 s52, s52, 65536
    s_add_u32 m0, s63, 12288
    s_nop 0
    buffer_load_dwordx4 v2, s[32:35], s52 offen offset:0 nt lds
    s_waitcnt vmcnt(5)
    s_add_u32 m0, s63, 13184
    s_nop 0
    buffer_load_dwordx4 v2, s[32:35], s52 offen offset:128 nt lds
    s_waitcnt vmcnt(5)
    s_add_u32 m0, s63, 12288
    s_nop 0
    buffer_load_dwordx4 v2, s[32:35], s52 offen offset:2048 nt lds
    s_waitcnt vmcnt(5)
    s_add_u32 m0, s63, 13184
    s_nop 0
    buffer_load_dwordx4 v2, s[32:35], s52 offen offset:2176 nt lds
    s_waitcnt vmcnt(5)
    s_add_u32 s52, s52, 65536
    s_add_u32 m0, s63, 16384
    s_nop 0
    buffer_load_dwordx4 v2, s[32:35], s52 offen offset:0 nt lds
    s_waitcnt vmcnt(5)
    s_add_u32 m0, s63, 17280
    s_nop 0
    buffer_load_dwordx4 v2, s[32:35], s52 offen offset:128 nt lds
    s_waitcnt vmcnt(5)
    s_add_u32 m0, s63, 16384
    s_nop 0
    buffer_load_dwordx4 v2, s[32:35], s52 offen offset:2048 nt lds
    s_waitcnt vmcnt(5)
    s_add_u32 m0, s63, 17280
    s_nop 0
    buffer_load_dwordx4 v2, s[32:35], s52 offen offset:2176 nt lds
    s_barrier
    ds_read_b128 v[16:19], v3 offset:8704
    ds_read_b128 v[20:23], v3 offset:8832
    s_waitcnt lgkmcnt(0)
    s_mul_i32 s49, s76, 0x9e3779b1
    s_mul_i32 s77, s48, 0x85ebca6c
    s_add_u32 s49, s49, s77
    s_add_u32 s49, s49, 0x7f4a7c15
    s_andn2_b32 s77, 2, s48
    s_andn2_b32 s49, s49, 2
    s_or_b32 s49, s49, s77
    v_cndmask_b32 v24, 0, v16, s[54:55]
    v_cndmask_b32 v25, 0, v17, s[54:55]
    v_cndmask_b32 v26, 0, v18, s[54:55]
    v_cndmask_b32 v27, 0, v19, s[54:55]
    v_cndmask_b32 v28, 0, v20, s[54:55]
    v_cndmask_b32 v29, 0, v21, s[54:55]
    v_cndmask_b32 v30, 0, v22, s[54:55]
    v_cndmask_b32 v31, 0, v23, s[54:55]
    v_cndmask_b32 v16, v16, 0, s[54:55]
    v_cndmask_b32 v17, v17, 0, s[54:55]
    v_cndmask_b32 v18, v18, 0, s[54:55]
    v_cndmask_b32 v19, v19, 0, s[54:55]
    v_cndmask_b32 v20, v20, 0, s[54:55]
    v_cndmask_b32 v21, v21, 0, s[54:55]
    v_cndmask_b32 v22, v22, 0, s[54:55]
    v_cndmask_b32 v23, v23, 0, s[54:55]
    v_lshlrev_b32 v3, 5, v1
    s_lshl_b32 s51, s3, 11
    s_add_u32 s51, s51, 8192
    v_add_u32 v3, s51, v3
    v_mfma_f32_16x16x32_bf16 v[32:35], v[96:99], v[16:19], 0
    v_mfma_f32_16x16x32_bf16 v[32:35], v[100:103], v[20:23], v[32:35]
    v_mfma_f32_16x16x32_bf16 v[32:35], v[104:107], v[24:27], v[32:35]
    v_mfma_f32_16x16x32_bf16 v[32:35], v[108:111], v[28:31], v[32:35]
    v_mfma_f32_16x16x32_bf16 v[36:39], v[112:115], v[16:19], 0
    v_mfma_f32_16x16x32_bf16 v[36:39], v[116:119], v[20:23], v[36:39]
    v_mfma_f32_16x16x32_bf16 v[36:39], v[120:123], v[24:27], v[36:39]
    v_mfma_f32_16x16x32_bf16 v[36:39], v[124:127], v[28:31], v[36:39]
    s_waitcnt vmcnt(5)
    s_add_u32 s52, s52, 65536
    buffer_load_dwordx4 v[96:99], v2, s[32:35], s52 offen offset:0 nt
    s_nop 0
    v_cndmask_b32 v9, v34, v33, s[56:57]
    v_cndmask_b32 v56, v32, v35, s[56:57]
    s_nop 1
    v_add_f32_dpp v56, v9, v56 quad_perm:[1,0,3,2] row_mask:0xf bank_mask:0xf
    v_mfma_f32_16x16x32_bf16 v[32:35], v[128:131], v[16:19], 0
    v_mfma_f32_16x16x32_bf16 v[32:35], v[132:135], v[20:23], v[32:35]
    v_mfma_f32_16x16x32_bf16 v[32:35], v[136:139], v[24:27], v[32:35]
    v_mfma_f32_16x16x32_bf16 v[32:35], v[140:143], v[28:31], v[32:35]
    v_cndmask_b32 v9, v38, v37, s[56:57]
    v_cndmask_b32 v57, v36, v39, s[56:57]
    s_nop 1
    v_add_f32_dpp v57, v9, v57 quad_perm:[1,0,3,2] row_mask:0xf bank_mask:0xf
    v_cvt_pk_bf16_f32 v11, v56, v57
    v_lshlrev_b32 v56, 16, v11
    v_and_b32 v57, s60, v11
    v_mul_f32 v56, s61, v56
    v_mul_f32 v57, s61, v57
    v_cvt_pk_bf16_f32 v11, v56, v57
    v_lshlrev_b32 v56, 16, v11
    v_and_b32 v57, s60, v11
    v_max3_f32 v6, v6, v56, v57
    s_waitcnt vmcnt(5)
    buffer_load_dwordx4 v[100:103], v2, s[32:35], s52 offen offset:128 nt
    v_mfma_f32_16x16x32_bf16 v[36:39], v[144:147], v[16:19], 0
    v_mfma_f32_16x16x32_bf16 v[36:39], v[148:151], v[20:23], v[36:39]
    v_mfma_f32_16x16x32_bf16 v[36:39], v[152:155], v[24:27], v[36:39]
    v_mfma_f32_16x16x32_bf16 v[36:39], v[156:159], v[28:31], v[36:39]
    v_cndmask_b32 v9, v34, v33, s[56:57]
    v_cndmask_b32 v58, v32, v35, s[56:57]
    s_nop 1
    v_add_f32_dpp v58, v9, v58 quad_perm:[1,0,3,2] row_mask:0xf bank_mask:0xf
    v_mfma_f32_16x16x32_bf16 v[32:35], v[160:163], v[16:19], 0
    v_mfma_f32_16x16x32_bf16 v[32:35], v[164:167], v[20:23], v[32:35]
    v_mfma_f32_16x16x32_bf16 v[32:35], v[168:171], v[24:27], v[32:35]
    v_mfma_f32_16x16x32_bf16 v[32:35], v[172:175], v[28:31], v[32:35]
    s_waitcnt vmcnt(5)
    buffer_load_dwordx4 v[104:107], v2, s[32:35], s52 offen offset:2048 nt
    v_cndmask_b32 v9, v38, v37, s[56:57]
    v_cndmask_b32 v59, v36, v39, s[56:57]
    s_nop 1
    v_add_f32_dpp v59, v9, v59 quad_perm:[1,0,3,2] row_mask:0xf bank_mask:0xf
    v_cvt_pk_bf16_f32 v11, v58, v59
    v_lshlrev_b32 v58, 16, v11
    v_and_b32 v59, s60, v11
    v_mul_f32 v58, s61, v58
    v_mul_f32 v59, s61, v59
    v_cvt_pk_bf16_f32 v11, v58, v59
    v_lshlrev_b32 v58, 16, v11
    v_and_b32 v59, s60, v11
    v_max3_f32 v6, v6, v58, v59
    v_mfma_f32_16x16x32_bf16 v[36:39], v[176:179], v[16:19], 0
    v_mfma_f32_16x16x32_bf16 v[36:39], v[180:183], v[20:23], v[36:39]
    v_mfma_f32_16x16x32_bf16 v[36:39], v[184:187], v[24:27], v[36:39]
    v_mfma_f32_16x16x32_bf16 v[36:39], v[188:191], v[28:31], v[36:39]
    s_waitcnt vmcnt(5)
    buffer_load_dwordx4 v[108:111], v2, s[32:35], s52 offen offset:2176 nt
    v_cndmask_b32 v9, v34, v33, s[56:57]
    v_cndmask_b32 v60, v32, v35, s[56:57]
    s_nop 1
    v_add_f32_dpp v60, v9, v60 quad_perm:[1,0,3,2] row_mask:0xf bank_mask:0xf
    v_mfma_f32_16x16x32_bf16 v[32:35], v[192:195], v[16:19], 0
    v_mfma_f32_16x16x32_bf16 v[32:35], v[196:199], v[20:23], v[32:35]
    v_mfma_f32_16x16x32_bf16 v[32:35], v[200:203], v[24:27], v[32:35]
    v_mfma_f32_16x16x32_bf16 v[32:35], v[204:207], v[28:31], v[32:35]
    v_cndmask_b32 v9, v38, v37, s[56:57]
    v_cndmask_b32 v61, v36, v39, s[56:57]
    s_nop 1
    v_add_f32_dpp v61, v9, v61 quad_perm:[1,0,3,2] row_mask:0xf bank_mask:0xf
    v_cvt_pk_bf16_f32 v11, v60, v61
    v_lshlrev_b32 v60, 16, v11
    v_and_b32 v61, s60, v11
    v_mul_f32 v60, s61, v60
    v_mul_f32 v61, s61, v61
    v_cvt_pk_bf16_f32 v11, v60, v61
    v_lshlrev_b32 v60, 16, v11
    v_and_b32 v61, s60, v11
    v_max3_f32 v6, v6, v60, v61
    s_waitcnt vmcnt(5)
    s_add_u32 s52, s52, 65536
    buffer_load_dwordx4 v[112:115], v2, s[32:35], s52 offen offset:0 nt
    v_mfma_f32_16x16x32_bf16 v[36:39], v[208:211], v[16:19], 0
    v_mfma_f32_16x16x32_bf16 v[36:39], v[212:215], v[20:23], v[36:39]
    v_mfma_f32_16x16x32_bf16 v[36:39], v[216:219], v[24:27], v[36:39]
    v_mfma_f32_16x16x32_bf16 v[36:39], v[220:223], v[28:31], v[36:39]
    v_cndmask_b32 v9, v34, v33, s[56:57]
    v_cndmask_b32 v62, v32, v35, s[56:57]
    s_nop 1
    v_add_f32_dpp v62, v9, v62 quad_perm:[1,0,3,2] row_mask:0xf bank_mask:0xf
    v_mfma_f32_16x16x32_bf16 v[32:35], v[224:227], v[16:19], 0
    v_mfma_f32_16x16x32_bf16 v[32:35], v[228:231], v[20:23], v[32:35]
    v_mfma_f32_16x16x32_bf16 v[32:35], v[232:235], v[24:27], v[32:35]
    v_mfma_f32_16x16x32_bf16 v[32:35], v[236:239], v[28:31], v[32:35]
    s_waitcnt vmcnt(5)
    buffer_load_dwordx4 v[116:119], v2, s[32:35], s52 offen offset:128 nt
    v_cndmask_b32 v9, v38, v37, s[56:57]
    v_cndmask_b32 v63, v36, v39, s[56:57]
    s_nop 1
    v_add_f32_dpp v63, v9, v63 quad_perm:[1,0,3,2] row_mask:0xf bank_mask:0xf
    v_cvt_pk_bf16_f32 v11, v62, v63
    v_lshlrev_b32 v62, 16, v11
    v_and_b32 v63, s60, v11
    v_mul_f32 v62, s61, v62
    v_mul_f32 v63, s61, v63
    v_cvt_pk_bf16_f32 v11, v62, v63
    v_lshlrev_b32 v62, 16, v11
    v_and_b32 v63, s60, v11
    v_max3_f32 v6, v6, v62, v63
    v_mfma_f32_16x16x32_bf16 v[36:39], v[240:243], v[16:19], 0
    v_mfma_f32_16x16x32_bf16 v[36:39], v[244:247], v[20:23], v[36:39]
    v_mfma_f32_16x16x32_bf16 v[36:39], v[248:251], v[24:27], v[36:39]
    v_mfma_f32_16x16x32_bf16 v[36:39], v[252:255], v[28:31], v[36:39]
    s_waitcnt vmcnt(5)
    buffer_load_dwordx4 v[120:123], v2, s[32:35], s52 offen offset:2048 nt
    v_cndmask_b32 v9, v34, v33, s[56:57]
    v_cndmask_b32 v64, v32, v35, s[56:57]
    s_nop 1
    v_add_f32_dpp v64, v9, v64 quad_perm:[1,0,3,2] row_mask:0xf bank_mask:0xf
    ds_read_b128 v[40:43], v15 offset:0
    ds_read_b128 v[44:47], v15 offset:1024
    ds_read_b128 v[48:51], v15 offset:2048
    ds_read_b128 v[52:55], v15 offset:3072
    s_waitcnt vmcnt(5)
    buffer_load_dwordx4 v[124:127], v2, s[32:35], s52 offen offset:2176 nt
    s_waitcnt lgkmcnt(0)
    v_mfma_f32_16x16x32_bf16 v[32:35], v[40:43], v[16:19], 0
    v_mfma_f32_16x16x32_bf16 v[32:35], v[44:47], v[20:23], v[32:35]
    v_mfma_f32_16x16x32_bf16 v[32:35], v[48:51], v[24:27], v[32:35]
    v_mfma_f32_16x16x32_bf16 v[32:35], v[52:55], v[28:31], v[32:35]
    v_cndmask_b32 v9, v38, v37, s[56:57]
    v_cndmask_b32 v65, v36, v39, s[56:57]
    s_nop 1
    v_add_f32_dpp v65, v9, v65 quad_perm:[1,0,3,2] row_mask:0xf bank_mask:0xf
    v_cvt_pk_bf16_f32 v11, v64, v65
    v_lshlrev_b32 v64, 16, v11
    v_and_b32 v65, s60, v11
    v_mul_f32 v64, s61, v64
    v_mul_f32 v65, s61, v65
    v_cvt_pk_bf16_f32 v11, v64, v65
    v_lshlrev_b32 v64, 16, v11
    v_and_b32 v65, s60, v11
    v_max3_f32 v6, v6, v64, v65
    s_waitcnt vmcnt(5)
    s_add_u32 s52, s52, 65536
    buffer_load_dwordx4 v[128:131], v2, s[32:35], s52 offen offset:0 nt
    ds_read_b128 v[40:43], v15 offset:4096
    ds_read_b128 v[44:47], v15 offset:5120
    ds_read_b128 v[48:51], v15 offset:6144
    ds_read_b128 v[52:55], v15 offset:7168
    s_waitcnt vmcnt(5)
    buffer_load_dwordx4 v[132:135], v2, s[32:35], s52 offen offset:128 nt
    s_waitcnt lgkmcnt(0)
    v_mfma_f32_16x16x32_bf16 v[36:39], v[40:43], v[16:19], 0
    v_mfma_f32_16x16x32_bf16 v[36:39], v[44:47], v[20:23], v[36:39]
    v_mfma_f32_16x16x32_bf16 v[36:39], v[48:51], v[24:27], v[36:39]
    v_mfma_f32_16x16x32_bf16 v[36:39], v[52:55], v[28:31], v[36:39]
    v_cndmask_b32 v9, v34, v33, s[56:57]
    v_cndmask_b32 v66, v32, v35, s[56:57]
    s_nop 1
    v_add_f32_dpp v66, v9, v66 quad_perm:[1,0,3,2] row_mask:0xf bank_mask:0xf
    ds_read_b128 v[40:43], v15 offset:8192
    ds_read_b128 v[44:47], v15 offset:9216
    ds_read_b128 v[48:51], v15 offset:10240
    ds_read_b128 v[52:55], v15 offset:11264
    s_waitcnt vmcnt(5)
    buffer_load_dwordx4 v[136:139], v2, s[32:35], s52 offen offset:2048 nt
    s_waitcnt lgkmcnt(0)
    v_mfma_f32_16x16x32_bf16 v[32:35], v[40:43], v[16:19], 0
    v_mfma_f32_16x16x32_bf16 v[32:35], v[44:47], v[20:23], v[32:35]
    v_mfma_f32_16x16x32_bf16 v[32:35], v[48:51], v[24:27], v[32:35]
    v_mfma_f32_16x16x32_bf16 v[32:35], v[52:55], v[28:31], v[32:35]
    v_cndmask_b32 v9, v38, v37, s[56:57]
    v_cndmask_b32 v67, v36, v39, s[56:57]
    s_nop 1
    v_add_f32_dpp v67, v9, v67 quad_perm:[1,0,3,2] row_mask:0xf bank_mask:0xf
    v_cvt_pk_bf16_f32 v11, v66, v67
    v_lshlrev_b32 v66, 16, v11
    v_and_b32 v67, s60, v11
    v_mul_f32 v66, s61, v66
    v_mul_f32 v67, s61, v67
    v_cvt_pk_bf16_f32 v11, v66, v67
    v_lshlrev_b32 v66, 16, v11
    v_and_b32 v67, s60, v11
    v_max3_f32 v6, v6, v66, v67
    s_waitcnt vmcnt(5)
    buffer_load_dwordx4 v[140:143], v2, s[32:35], s52 offen offset:2176 nt
    ds_read_b128 v[40:43], v15 offset:12288
    ds_read_b128 v[44:47], v15 offset:13312
    ds_read_b128 v[48:51], v15 offset:14336
    ds_read_b128 v[52:55], v15 offset:15360
    s_waitcnt vmcnt(5)
    s_add_u32 s52, s52, 65536
    buffer_load_dwordx4 v[144:147], v2, s[32:35], s52 offen offset:0 nt
    s_waitcnt lgkmcnt(0)
    v_mfma_f32_16x16x32_bf16 v[36:39], v[40:43], v[16:19], 0
    v_mfma_f32_16x16x32_bf16 v[36:39], v[44:47], v[20:23], v[36:39]
    v_mfma_f32_16x16x32_bf16 v[36:39], v[48:51], v[24:27], v[36:39]
    v_mfma_f32_16x16x32_bf16 v[36:39], v[52:55], v[28:31], v[36:39]
    v_cndmask_b32 v9, v34, v33, s[56:57]
    v_cndmask_b32 v68, v32, v35, s[56:57]
    s_nop 1
    v_add_f32_dpp v68, v9, v68 quad_perm:[1,0,3,2] row_mask:0xf bank_mask:0xf
    ds_read_b128 v[40:43], v15 offset:16384
    ds_read_b128 v[44:47], v15 offset:17408
    ds_read_b128 v[48:51], v15 offset:18432
    ds_read_b128 v[52:55], v15 offset:19456
    s_waitcnt vmcnt(5)
    buffer_load_dwordx4 v[148:151], v2, s[32:35], s52 offen offset:128 nt
    s_waitcnt lgkmcnt(0)
    v_mfma_f32_16x16x32_bf16 v[32:35], v[40:43], v[16:19], 0
    v_mfma_f32_16x16x32_bf16 v[32:35], v[44:47], v[20:23], v[32:35]
    v_mfma_f32_16x16x32_bf16 v[32:35], v[48:51], v[24:27], v[32:35]
    v_mfma_f32_16x16x32_bf16 v[32:35], v[52:55], v[28:31], v[32:35]
    v_cndmask_b32 v9, v38, v37, s[56:57]
    v_cndmask_b32 v69, v36, v39, s[56:57]
    s_nop 1
    v_add_f32_dpp v69, v9, v69 quad_perm:[1,0,3,2] row_mask:0xf bank_mask:0xf
    v_cvt_pk_bf16_f32 v11, v68, v69
    v_lshlrev_b32 v68, 16, v11
    v_and_b32 v69, s60, v11
    v_mul_f32 v68, s61, v68
    v_mul_f32 v69, s61, v69
    v_cvt_pk_bf16_f32 v11, v68, v69
    v_lshlrev_b32 v68, 16, v11
    v_and_b32 v69, s60, v11
    v_max3_f32 v6, v6, v68, v69
    s_waitcnt vmcnt(5)
    buffer_load_dwordx4 v[152:155], v2, s[32:35], s52 offen offset:2048 nt
    v_mfma_f32_16x16x32_bf16 v[36:39], v[96:99], v[16:19], 0
    v_mfma_f32_16x16x32_bf16 v[36:39], v[100:103], v[20:23], v[36:39]
    v_mfma_f32_16x16x32_bf16 v[36:39], v[104:107], v[24:27], v[36:39]
    v_mfma_f32_16x16x32_bf16 v[36:39], v[108:111], v[28:31], v[36:39]
    v_cndmask_b32 v9, v34, v33, s[56:57]
    v_cndmask_b32 v70, v32, v35, s[56:57]
    s_nop 1
    v_add_f32_dpp v70, v9, v70 quad_perm:[1,0,3,2] row_mask:0xf bank_mask:0xf
    v_mfma_f32_16x16x32_bf16 v[32:35], v[112:115], v[16:19], 0
    v_mfma_f32_16x16x32_bf16 v[32:35], v[116:119], v[20:23], v[32:35]
    v_mfma_f32_16x16x32_bf16 v[32:35], v[120:123], v[24:27], v[32:35]
    v_mfma_f32_16x16x32_bf16 v[32:35], v[124:127], v[28:31], v[32:35]
    s_waitcnt vmcnt(5)
    buffer_load_dwordx4 v[156:159], v2, s[32:35], s52 offen offset:2176 nt
    v_cndmask_b32 v9, v38, v37, s[56:57]
    v_cndmask_b32 v71, v36, v39, s[56:57]
    s_nop 1
    v_add_f32_dpp v71, v9, v71 quad_perm:[1,0,3,2] row_mask:0xf bank_mask:0xf
    v_cvt_pk_bf16_f32 v11, v70, v71
    v_lshlrev_b32 v70, 16, v11
    v_and_b32 v71, s60, v11
    v_mul_f32 v70, s61, v70
    v_mul_f32 v71, s61, v71
    v_cvt_pk_bf16_f32 v11, v70, v71
    v_lshlrev_b32 v70, 16, v11
    v_and_b32 v71, s60, v11
    v_max3_f32 v6, v6, v70, v71
    s_waitcnt vmcnt(5)
    s_add_u32 s52, s52, 65536
    buffer_load_dwordx4 v[160:163], v2, s[32:35], s52 offen offset:0 nt
    s_waitcnt vmcnt(5)
    buffer_load_dwordx4 v[164:167], v2, s[32:35], s52 offen offset:128 nt
    v_mfma_f32_16x16x32_bf16 v[36:39], v[128:131], v[16:19], 0
    v_mfma_f32_16x16x32_bf16 v[36:39], v[132:135], v[20:23], v[36:39]
    v_mfma_f32_16x16x32_bf16 v[36:39], v[136:139], v[24:27], v[36:39]
    v_mfma_f32_16x16x32_bf16 v[36:39], v[140:143], v[28:31], v[36:39]
    v_cndmask_b32 v9, v34, v33, s[56:57]
    v_cndmask_b32 v72, v32, v35, s[56:57]
    s_nop 1
    v_add_f32_dpp v72, v9, v72 quad_perm:[1,0,3,2] row_mask:0xf bank_mask:0xf
    s_waitcnt vmcnt(5)
    buffer_load_dwordx4 v[168:171], v2, s[32:35], s52 offen offset:2048 nt
    s_waitcnt vmcnt(5)
    buffer_load_dwordx4 v[172:175], v2, s[32:35], s52 offen offset:2176 nt
    s_waitcnt vmcnt(5)
    s_add_u32 s52, s52, 65536
    buffer_load_dwordx4 v[176:179], v2, s[32:35], s52 offen offset:0 nt
    s_waitcnt vmcnt(5)
    buffer_load_dwordx4 v[180:183], v2, s[32:35], s52 offen offset:128 nt
    v_mfma_f32_16x16x32_bf16 v[32:35], v[144:147], v[16:19], 0
    v_mfma_f32_16x16x32_bf16 v[32:35], v[148:151], v[20:23], v[32:35]
    v_mfma_f32_16x16x32_bf16 v[32:35], v[152:155], v[24:27], v[32:35]
    v_mfma_f32_16x16x32_bf16 v[32:35], v[156:159], v[28:31], v[32:35]
    v_cndmask_b32 v9, v38, v37, s[56:57]
    v_cndmask_b32 v73, v36, v39, s[56:57]
    s_nop 1
    v_add_f32_dpp v73, v9, v73 quad_perm:[1,0,3,2] row_mask:0xf bank_mask:0xf
    v_cvt_pk_bf16_f32 v11, v72, v73
    v_lshlrev_b32 v72, 16, v11
    v_and_b32 v73, s60, v11
    v_mul_f32 v72, s61, v72
    v_mul_f32 v73, s61, v73
    v_cvt_pk_bf16_f32 v11, v72, v73
    v_lshlrev_b32 v72, 16, v11
    v_and_b32 v73, s60, v11
    v_max3_f32 v6, v6, v72, v73
    s_waitcnt vmcnt(5)
    buffer_load_dwordx4 v[184:187], v2, s[32:35], s52 offen offset:2048 nt
    s_waitcnt vmcnt(5)
    buffer_load_dwordx4 v[188:191], v2, s[32:35], s52 offen offset:2176 nt
    s_waitcnt vmcnt(5)
    s_add_u32 s52, s52, 65536
    buffer_load_dwordx4 v[192:195], v2, s[32:35], s52 offen offset:0 nt
    s_waitcnt vmcnt(5)
    buffer_load_dwordx4 v[196:199], v2, s[32:35], s52 offen offset:128 nt
    v_mfma_f32_16x16x32_bf16 v[36:39], v[160:163], v[16:19], 0
    v_mfma_f32_16x16x32_bf16 v[36:39], v[164:167], v[20:23], v[36:39]
    v_mfma_f32_16x16x32_bf16 v[36:39], v[168:171], v[24:27], v[36:39]
    v_mfma_f32_16x16x32_bf16 v[36:39], v[172:175], v[28:31], v[36:39]
    v_cndmask_b32 v9, v34, v33, s[56:57]
    v_cndmask_b32 v74, v32, v35, s[56:57]
    s_nop 1
    v_add_f32_dpp v74, v9, v74 quad_perm:[1,0,3,2] row_mask:0xf bank_mask:0xf
    s_waitcnt vmcnt(5)
    buffer_load_dwordx4 v[200:203], v2, s[32:35], s52 offen offset:2048 nt
    s_waitcnt vmcnt(5)
    buffer_load_dwordx4 v[204:207], v2, s[32:35], s52 offen offset:2176 nt
    s_waitcnt vmcnt(5)
    s_add_u32 s52, s52, 65536
    buffer_load_dwordx4 v[208:211], v2, s[32:35], s52 offen offset:0 nt
    s_waitcnt vmcnt(5)
    buffer_load_dwordx4 v[212:215], v2, s[32:35], s52 offen offset:128 nt
    v_mfma_f32_16x16x32_bf16 v[32:35], v[176:179], v[16:19], 0
    v_mfma_f32_16x16x32_bf16 v[32:35], v[180:183], v[20:23], v[32:35]
    v_mfma_f32_16x16x32_bf16 v[32:35], v[184:187], v[24:27], v[32:35]
    v_mfma_f32_16x16x32_bf16 v[32:35], v[188:191], v[28:31], v[32:35]
    v_cndmask_b32 v9, v38, v37, s[56:57]
    v_cndmask_b32 v75, v36, v39, s[56:57]
    s_nop 1
    v_add_f32_dpp v75, v9, v75 quad_perm:[1,0,3,2] row_mask:0xf bank_mask:0xf
    v_cvt_pk_bf16_f32 v11, v74, v75
    v_lshlrev_b32 v74, 16, v11
    v_and_b32 v75, s60, v11
    v_mul_f32 v74, s61, v74
    v_mul_f32 v75, s61, v75
    v_cvt_pk_bf16_f32 v11, v74, v75
    v_lshlrev_b32 v74, 16, v11
    v_and_b32 v75, s60, v11
    v_max3_f32 v6, v6, v74, v75
    s_waitcnt vmcnt(5)
    buffer_load_dwordx4 v[216:219], v2, s[32:35], s52 offen offset:2048 nt
    s_waitcnt vmcnt(5)
    buffer_load_dwordx4 v[220:223], v2, s[32:35], s52 offen offset:2176 nt
    s_waitcnt vmcnt(5)
    s_add_u32 s52, s52, 65536
    buffer_load_dwordx4 v[224:227], v2, s[32:35], s52 offen offset:0 nt
    s_waitcnt vmcnt(5)
    buffer_load_dwordx4 v[228:231], v2, s[32:35], s52 offen offset:128 nt
    v_mfma_f32_16x16x32_bf16 v[36:39], v[192:195], v[16:19], 0
    v_mfma_f32_16x16x32_bf16 v[36:39], v[196:199], v[20:23], v[36:39]
    v_mfma_f32_16x16x32_bf16 v[36:39], v[200:203], v[24:27], v[36:39]
    v_mfma_f32_16x16x32_bf16 v[36:39], v[204:207], v[28:31], v[36:39]
    v_cndmask_b32 v9, v34, v33, s[56:57]
    v_cndmask_b32 v76, v32, v35, s[56:57]
    s_nop 1
    v_add_f32_dpp v76, v9, v76 quad_perm:[1,0,3,2] row_mask:0xf bank_mask:0xf
    s_waitcnt vmcnt(5)
    buffer_load_dwordx4 v[232:235], v2, s[32:35], s52 offen offset:2048 nt
    s_waitcnt vmcnt(5)
    buffer_load_dwordx4 v[236:239], v2, s[32:35], s52 offen offset:2176 nt
    s_waitcnt vmcnt(5)
    s_add_u32 s52, s52, 65536
    buffer_load_dwordx4 v[240:243], v2, s[32:35], s52 offen offset:0 nt
    s_waitcnt vmcnt(5)
    buffer_load_dwordx4 v[244:247], v2, s[32:35], s52 offen offset:128 nt
    v_mfma_f32_16x16x32_bf16 v[32:35], v[208:211], v[16:19], 0
    v_mfma_f32_16x16x32_bf16 v[32:35], v[212:215], v[20:23], v[32:35]
    v_mfma_f32_16x16x32_bf16 v[32:35], v[216:219], v[24:27], v[32:35]
    v_mfma_f32_16x16x32_bf16 v[32:35], v[220:223], v[28:31], v[32:35]
    v_cndmask_b32 v9, v38, v37, s[56:57]
    v_cndmask_b32 v77, v36, v39, s[56:57]
    s_nop 1
    v_add_f32_dpp v77, v9, v77 quad_perm:[1,0,3,2] row_mask:0xf bank_mask:0xf
    v_cvt_pk_bf16_f32 v11, v76, v77
    v_lshlrev_b32 v76, 16, v11
    v_and_b32 v77, s60, v11
    v_mul_f32 v76, s61, v76
    v_mul_f32 v77, s61, v77
    v_cvt_pk_bf16_f32 v11, v76, v77
    v_lshlrev_b32 v76, 16, v11
    v_and_b32 v77, s60, v11
    v_max3_f32 v6, v6, v76, v77
    s_waitcnt vmcnt(5)
    buffer_load_dwordx4 v[248:251], v2, s[32:35], s52 offen offset:2048 nt
    s_waitcnt vmcnt(5)
    buffer_load_dwordx4 v[252:255], v2, s[32:35], s52 offen offset:2176 nt
    s_waitcnt vmcnt(5)
    s_add_u32 s52, s52, 65536
    buffer_load_dwordx4 v[96:99], v2, s[32:35], s52 offen offset:0 nt
    s_waitcnt vmcnt(5)
    buffer_load_dwordx4 v[100:103], v2, s[32:35], s52 offen offset:128 nt
    v_mfma_f32_16x16x32_bf16 v[36:39], v[224:227], v[16:19], 0
    v_mfma_f32_16x16x32_bf16 v[36:39], v[228:231], v[20:23], v[36:39]
    v_mfma_f32_16x16x32_bf16 v[36:39], v[232:235], v[24:27], v[36:39]
    v_mfma_f32_16x16x32_bf16 v[36:39], v[236:239], v[28:31], v[36:39]
    v_cndmask_b32 v9, v34, v33, s[56:57]
    v_cndmask_b32 v78, v32, v35, s[56:57]
    s_nop 1
    v_add_f32_dpp v78, v9, v78 quad_perm:[1,0,3,2] row_mask:0xf bank_mask:0xf
    s_waitcnt vmcnt(5)
    buffer_load_dwordx4 v[104:107], v2, s[32:35], s52 offen offset:2048 nt
    s_waitcnt vmcnt(5)
    buffer_load_dwordx4 v[108:111], v2, s[32:35], s52 offen offset:2176 nt
    s_waitcnt vmcnt(5)
    s_add_u32 s52, s52, 65536
    buffer_load_dwordx4 v[112:115], v2, s[32:35], s52 offen offset:0 nt
    s_waitcnt vmcnt(5)
    buffer_load_dwordx4 v[116:119], v2, s[32:35], s52 offen offset:128 nt
    v_mfma_f32_16x16x32_bf16 v[32:35], v[240:243], v[16:19], 0
    v_mfma_f32_16x16x32_bf16 v[32:35], v[244:247], v[20:23], v[32:35]
    v_mfma_f32_16x16x32_bf16 v[32:35], v[248:251], v[24:27], v[32:35]
    v_mfma_f32_16x16x32_bf16 v[32:35], v[252:255], v[28:31], v[32:35]
    v_cndmask_b32 v9, v38, v37, s[56:57]
    v_cndmask_b32 v79, v36, v39, s[56:57]
    s_nop 1
    v_add_f32_dpp v79, v9, v79 quad_perm:[1,0,3,2] row_mask:0xf bank_mask:0xf
    v_cvt_pk_bf16_f32 v11, v78, v79
    v_lshlrev_b32 v78, 16, v11
    v_and_b32 v79, s60, v11
    v_mul_f32 v78, s61, v78
    v_mul_f32 v79, s61, v79
    v_cvt_pk_bf16_f32 v11, v78, v79
    v_lshlrev_b32 v78, 16, v11
    v_and_b32 v79, s60, v11
    v_max3_f32 v6, v6, v78, v79
    s_waitcnt vmcnt(5)
    buffer_load_dwordx4 v[120:123], v2, s[32:35], s52 offen offset:2048 nt
    s_waitcnt vmcnt(5)
    buffer_load_dwordx4 v[124:127], v2, s[32:35], s52 offen offset:2176 nt
    s_waitcnt vmcnt(5)
    s_add_u32 s52, s52, 65536
    buffer_load_dwordx4 v[128:131], v2, s[32:35], s52 offen offset:0 nt
    s_waitcnt vmcnt(5)
    buffer_load_dwordx4 v[132:135], v2, s[32:35], s52 offen offset:128 nt
    v_mfma_f32_16x16x32_bf16 v[36:39], v[96:99], v[16:19], 0
    v_mfma_f32_16x16x32_bf16 v[36:39], v[100:103], v[20:23], v[36:39]
    v_mfma_f32_16x16x32_bf16 v[36:39], v[104:107], v[24:27], v[36:39]
    v_mfma_f32_16x16x32_bf16 v[36:39], v[108:111], v[28:31], v[36:39]
    v_cndmask_b32 v9, v34, v33, s[56:57]
    v_cndmask_b32 v80, v32, v35, s[56:57]
    s_nop 1
    v_add_f32_dpp v80, v9, v80 quad_perm:[1,0,3,2] row_mask:0xf bank_mask:0xf
    s_waitcnt vmcnt(5)
    buffer_load_dwordx4 v[136:139], v2, s[32:35], s52 offen offset:2048 nt
    s_waitcnt vmcnt(5)
    buffer_load_dwordx4 v[140:143], v2, s[32:35], s52 offen offset:2176 nt
    s_waitcnt vmcnt(5)
    buffer_load_dwordx4 v[144:147], v14, s[36:39], s50 offen offset:0 nt
    s_waitcnt vmcnt(5)
    buffer_load_dwordx4 v[148:151], v14, s[36:39], s50 offen offset:1024 nt
    v_mfma_f32_16x16x32_bf16 v[32:35], v[112:115], v[16:19], 0
    v_mfma_f32_16x16x32_bf16 v[32:35], v[116:119], v[20:23], v[32:35]
    v_mfma_f32_16x16x32_bf16 v[32:35], v[120:123], v[24:27], v[32:35]
    v_mfma_f32_16x16x32_bf16 v[32:35], v[124:127], v[28:31], v[32:35]
    v_cndmask_b32 v9, v38, v37, s[56:57]
    v_cndmask_b32 v81, v36, v39, s[56:57]
    s_nop 1
    v_add_f32_dpp v81, v9, v81 quad_perm:[1,0,3,2] row_mask:0xf bank_mask:0xf
    v_cvt_pk_bf16_f32 v11, v80, v81
    v_lshlrev_b32 v80, 16, v11
    v_and_b32 v81, s60, v11
    v_mul_f32 v80, s61, v80
    v_mul_f32 v81, s61, v81
    v_cvt_pk_bf16_f32 v11, v80, v81
    v_lshlrev_b32 v80, 16, v11
    v_and_b32 v81, s60, v11
    v_max3_f32 v6, v6, v80, v81
    s_waitcnt vmcnt(5)
    buffer_load_dwordx4 v[152:155], v14, s[36:39], s50 offen offset:2048 nt
    s_waitcnt vmcnt(5)
    buffer_load_dwordx4 v[156:159], v14, s[36:39], s50 offen offset:3072 nt
    s_waitcnt vmcnt(5)
    s_add_u32 s50, s50, 65536
    buffer_load_dwordx4 v[160:163], v14, s[36:39], s50 offen offset:0 nt
    s_waitcnt vmcnt(5)
    buffer_load_dwordx4 v[164:167], v14, s[36:39], s50 offen offset:1024 nt
    v_mfma_f32_16x16x32_bf16 v[36:39], v[128:131], v[16:19], 0
    v_mfma_f32_16x16x32_bf16 v[36:39], v[132:135], v[20:23], v[36:39]
    v_mfma_f32_16x16x32_bf16 v[36:39], v[136:139], v[24:27], v[36:39]
    v_mfma_f32_16x16x32_bf16 v[36:39], v[140:143], v[28:31], v[36:39]
    v_cndmask_b32 v9, v34, v33, s[56:57]
    v_cndmask_b32 v82, v32, v35, s[56:57]
    s_nop 1
    v_add_f32_dpp v82, v9, v82 quad_perm:[1,0,3,2] row_mask:0xf bank_mask:0xf
    s_nop 2
    v_cndmask_b32 v9, v38, v37, s[56:57]
    v_cndmask_b32 v83, v36, v39, s[56:57]
    s_nop 1
    v_add_f32_dpp v83, v9, v83 quad_perm:[1,0,3,2] row_mask:0xf bank_mask:0xf
    v_cvt_pk_bf16_f32 v11, v82, v83
    v_lshlrev_b32 v82, 16, v11
    v_and_b32 v83, s60, v11
    v_mul_f32 v82, s61, v82
    v_mul_f32 v83, s61, v83
    v_cvt_pk_bf16_f32 v11, v82, v83
    v_lshlrev_b32 v82, 16, v11
    v_and_b32 v83, s60, v11
    v_max3_f32 v6, v6, v82, v83
    s_waitcnt vmcnt(5)
    buffer_load_dwordx4 v[168:171], v14, s[36:39], s50 offen offset:2048 nt
    v_max_f32_dpp v6, v6, v6 quad_perm:[1,0,3,2] row_mask:0xf bank_mask:0xf
    s_nop 1
    v_max_f32_dpp v6, v6, v6 quad_perm:[2,3,0,1] row_mask:0xf bank_mask:0xf
    v_mov_b32 v9, v6
    s_nop 1
    v_permlane16_swap_b32 v6, v9
    v_max_f32 v6, v6, v9
    v_mov_b32 v9, v6
    s_nop 1
    v_permlane32_swap_b32 v6, v9
    v_max_f32 v6, v6, v9
    v_mul_f32 v8, s53, v6
    v_mov_b32 v11, 1
    s_mov_b64 exec, 1
    ds_add_u32 v10, v11 offset:4
    s_mov_b64 exec, -1
    s_waitcnt lgkmcnt(0)
    v_fma_f32 v56, v56, s53, -v8
    v_exp_f32 v56, v56
    s_nop 0
    v_add_f32 v7, v7, v56
    v_cvt_pk_bf16_f32 v56, v56, v56
    s_nop 1
    v_and_b32_dpp v48, v56, v4 quad_perm:[0,0,0,0] row_mask:0xf bank_mask:0xf
    v_and_b32_dpp v49, v56, v5 quad_perm:[0,0,0,0] row_mask:0xf bank_mask:0xf
    s_nop 1
    v_mfma_f32_16x16x16_bf16 v[40:43], v[48:49], v[144:145], 0
    v_mfma_f32_16x16x16_bf16 v[44:47], v[48:49], v[146:147], 0
    s_waitcnt vmcnt(5)
    buffer_load_dwordx4 v[172:175], v14, s[36:39], s50 offen offset:3072 nt
    v_and_b32_dpp v50, v56, v4 quad_perm:[1,1,1,1] row_mask:0xf bank_mask:0xf
    v_and_b32_dpp v51, v56, v5 quad_perm:[1,1,1,1] row_mask:0xf bank_mask:0xf
    s_nop 1
    v_mfma_f32_16x16x16_bf16 v[40:43], v[50:51], v[148:149], v[40:43]
    v_mfma_f32_16x16x16_bf16 v[44:47], v[50:51], v[150:151], v[44:47]
    s_waitcnt vmcnt(5)
    s_add_u32 s50, s50, 65536
    buffer_load_dwordx4 v[176:179], v14, s[36:39], s50 offen offset:0 nt
    v_and_b32_dpp v52, v56, v4 quad_perm:[2,2,2,2] row_mask:0xf bank_mask:0xf
    v_and_b32_dpp v53, v56, v5 quad_perm:[2,2,2,2] row_mask:0xf bank_mask:0xf
    s_nop 1
    v_mfma_f32_16x16x16_bf16 v[40:43], v[52:53], v[152:153], v[40:43]
    v_mfma_f32_16x16x16_bf16 v[44:47], v[52:53], v[154:155], v[44:47]
    s_waitcnt vmcnt(5)
    buffer_load_dwordx4 v[180:183], v14, s[36:39], s50 offen offset:1024 nt
    v_and_b32_dpp v54, v56, v4 quad_perm:[3,3,3,3] row_mask:0xf bank_mask:0xf
    v_and_b32_dpp v55, v56, v5 quad_perm:[3,3,3,3] row_mask:0xf bank_mask:0xf
    s_nop 1
    v_mfma_f32_16x16x16_bf16 v[40:43], v[54:55], v[156:157], v[40:43]
    v_mfma_f32_16x16x16_bf16 v[44:47], v[54:55], v[158:159], v[44:47]
    v_fma_f32 v57, v57, s53, -v8
    v_exp_f32 v57, v57
    s_nop 0
    v_add_f32 v7, v7, v57
    v_cvt_pk_bf16_f32 v57, v57, v57
    s_waitcnt vmcnt(5)
    buffer_load_dwordx4 v[184:187], v14, s[36:39], s50 offen offset:2048 nt
    v_and_b32_dpp v48, v57, v4 quad_perm:[0,0,0,0] row_mask:0xf bank_mask:0xf
    v_and_b32_dpp v49, v57, v5 quad_perm:[0,0,0,0] row_mask:0xf bank_mask:0xf
    s_nop 1
    v_mfma_f32_16x16x16_bf16 v[40:43], v[48:49], v[160:161], v[40:43]
    v_mfma_f32_16x16x16_bf16 v[44:47], v[48:49], v[162:163], v[44:47]
    s_waitcnt vmcnt(5)
    buffer_load_dwordx4 v[188:191], v14, s[36:39], s50 offen offset:3072 nt
    v_and_b32_dpp v50, v57, v4 quad_perm:[1,1,1,1] row_mask:0xf bank_mask:0xf
    v_and_b32_dpp v51, v57, v5 quad_perm:[1,1,1,1] row_mask:0xf bank_mask:0xf
    s_nop 1
    v_mfma_f32_16x16x16_bf16 v[40:43], v[50:51], v[164:165], v[40:43]
    v_mfma_f32_16x16x16_bf16 v[44:47], v[50:51], v[166:167], v[44:47]
    s_waitcnt vmcnt(5)
    s_add_u32 s50, s50, 65536
    buffer_load_dwordx4 v[192:195], v14, s[36:39], s50 offen offset:0 nt
    v_and_b32_dpp v52, v57, v4 quad_perm:[2,2,2,2] row_mask:0xf bank_mask:0xf
    v_and_b32_dpp v53, v57, v5 quad_perm:[2,2,2,2] row_mask:0xf bank_mask:0xf
    s_nop 1
    v_mfma_f32_16x16x16_bf16 v[40:43], v[52:53], v[168:169], v[40:43]
    v_mfma_f32_16x16x16_bf16 v[44:47], v[52:53], v[170:171], v[44:47]
    s_waitcnt vmcnt(5)
    buffer_load_dwordx4 v[196:199], v14, s[36:39], s50 offen offset:1024 nt
    v_and_b32_dpp v54, v57, v4 quad_perm:[3,3,3,3] row_mask:0xf bank_mask:0xf
    v_and_b32_dpp v55, v57, v5 quad_perm:[3,3,3,3] row_mask:0xf bank_mask:0xf
    s_nop 1
    v_mfma_f32_16x16x16_bf16 v[40:43], v[54:55], v[172:173], v[40:43]
    v_mfma_f32_16x16x16_bf16 v[44:47], v[54:55], v[174:175], v[44:47]
    v_fma_f32 v58, v58, s53, -v8
    v_exp_f32 v58, v58
    s_nop 0
    v_add_f32 v7, v7, v58
    v_cvt_pk_bf16_f32 v58, v58, v58
    s_waitcnt vmcnt(5)
    buffer_load_dwordx4 v[200:203], v14, s[36:39], s50 offen offset:2048 nt
    v_and_b32_dpp v48, v58, v4 quad_perm:[0,0,0,0] row_mask:0xf bank_mask:0xf
    v_and_b32_dpp v49, v58, v5 quad_perm:[0,0,0,0] row_mask:0xf bank_mask:0xf
    s_nop 1
    v_mfma_f32_16x16x16_bf16 v[40:43], v[48:49], v[176:177], v[40:43]
    v_mfma_f32_16x16x16_bf16 v[44:47], v[48:49], v[178:179], v[44:47]
    s_waitcnt vmcnt(5)
    buffer_load_dwordx4 v[204:207], v14, s[36:39], s50 offen offset:3072 nt
    v_and_b32_dpp v50, v58, v4 quad_perm:[1,1,1,1] row_mask:0xf bank_mask:0xf
    v_and_b32_dpp v51, v58, v5 quad_perm:[1,1,1,1] row_mask:0xf bank_mask:0xf
    s_nop 1
    v_mfma_f32_16x16x16_bf16 v[40:43], v[50:51], v[180:181], v[40:43]
    v_mfma_f32_16x16x16_bf16 v[44:47], v[50:51], v[182:183], v[44:47]
    s_waitcnt vmcnt(5)
    s_add_u32 s50, s50, 65536
    buffer_load_dwordx4 v[208:211], v14, s[36:39], s50 offen offset:0 nt
    v_and_b32_dpp v52, v58, v4 quad_perm:[2,2,2,2] row_mask:0xf bank_mask:0xf
    v_and_b32_dpp v53, v58, v5 quad_perm:[2,2,2,2] row_mask:0xf bank_mask:0xf
    s_nop 1
    v_mfma_f32_16x16x16_bf16 v[40:43], v[52:53], v[184:185], v[40:43]
    v_mfma_f32_16x16x16_bf16 v[44:47], v[52:53], v[186:187], v[44:47]
    s_waitcnt vmcnt(5)
    buffer_load_dwordx4 v[212:215], v14, s[36:39], s50 offen offset:1024 nt
    v_and_b32_dpp v54, v58, v4 quad_perm:[3,3,3,3] row_mask:0xf bank_mask:0xf
    v_and_b32_dpp v55, v58, v5 quad_perm:[3,3,3,3] row_mask:0xf bank_mask:0xf
    s_nop 1
    v_mfma_f32_16x16x16_bf16 v[40:43], v[54:55], v[188:189], v[40:43]
    v_mfma_f32_16x16x16_bf16 v[44:47], v[54:55], v[190:191], v[44:47]
    v_fma_f32 v59, v59, s53, -v8
    v_exp_f32 v59, v59
    s_nop 0
    v_add_f32 v7, v7, v59
    v_cvt_pk_bf16_f32 v59, v59, v59
    s_waitcnt vmcnt(5)
    buffer_load_dwordx4 v[216:219], v14, s[36:39], s50 offen offset:2048 nt
    v_and_b32_dpp v48, v59, v4 quad_perm:[0,0,0,0] row_mask:0xf bank_mask:0xf
    v_and_b32_dpp v49, v59, v5 quad_perm:[0,0,0,0] row_mask:0xf bank_mask:0xf
    s_nop 1
    v_mfma_f32_16x16x16_bf16 v[40:43], v[48:49], v[192:193], v[40:43]
    v_mfma_f32_16x16x16_bf16 v[44:47], v[48:49], v[194:195], v[44:47]
    s_waitcnt vmcnt(5)
    buffer_load_dwordx4 v[220:223], v14, s[36:39], s50 offen offset:3072 nt
    v_and_b32_dpp v50, v59, v4 quad_perm:[1,1,1,1] row_mask:0xf bank_mask:0xf
    v_and_b32_dpp v51, v59, v5 quad_perm:[1,1,1,1] row_mask:0xf bank_mask:0xf
    s_nop 1
    v_mfma_f32_16x16x16_bf16 v[40:43], v[50:51], v[196:197], v[40:43]
    v_mfma_f32_16x16x16_bf16 v[44:47], v[50:51], v[198:199], v[44:47]
    s_waitcnt vmcnt(5)
    s_add_u32 s50, s50, 65536
    buffer_load_dwordx4 v[224:227], v14, s[36:39], s50 offen offset:0 nt
    v_and_b32_dpp v52, v59, v4 quad_perm:[2,2,2,2] row_mask:0xf bank_mask:0xf
    v_and_b32_dpp v53, v59, v5 quad_perm:[2,2,2,2] row_mask:0xf bank_mask:0xf
    s_nop 1
    v_mfma_f32_16x16x16_bf16 v[40:43], v[52:53], v[200:201], v[40:43]
    v_mfma_f32_16x16x16_bf16 v[44:47], v[52:53], v[202:203], v[44:47]
    s_waitcnt vmcnt(5)
    buffer_load_dwordx4 v[228:231], v14, s[36:39], s50 offen offset:1024 nt
    v_and_b32_dpp v54, v59, v4 quad_perm:[3,3,3,3] row_mask:0xf bank_mask:0xf
    v_and_b32_dpp v55, v59, v5 quad_perm:[3,3,3,3] row_mask:0xf bank_mask:0xf
    s_nop 1
    v_mfma_f32_16x16x16_bf16 v[40:43], v[54:55], v[204:205], v[40:43]
    v_mfma_f32_16x16x16_bf16 v[44:47], v[54:55], v[206:207], v[44:47]
    v_fma_f32 v60, v60, s53, -v8
    v_exp_f32 v60, v60
    s_nop 0
    v_add_f32 v7, v7, v60
    v_cvt_pk_bf16_f32 v60, v60, v60
    s_waitcnt vmcnt(5)
    buffer_load_dwordx4 v[232:235], v14, s[36:39], s50 offen offset:2048 nt
    v_and_b32_dpp v48, v60, v4 quad_perm:[0,0,0,0] row_mask:0xf bank_mask:0xf
    v_and_b32_dpp v49, v60, v5 quad_perm:[0,0,0,0] row_mask:0xf bank_mask:0xf
    s_nop 1
    v_mfma_f32_16x16x16_bf16 v[40:43], v[48:49], v[208:209], v[40:43]
    v_mfma_f32_16x16x16_bf16 v[44:47], v[48:49], v[210:211], v[44:47]
    s_waitcnt vmcnt(5)
    buffer_load_dwordx4 v[236:239], v14, s[36:39], s50 offen offset:3072 nt
    v_and_b32_dpp v50, v60, v4 quad_perm:[1,1,1,1] row_mask:0xf bank_mask:0xf
    v_and_b32_dpp v51, v60, v5 quad_perm:[1,1,1,1] row_mask:0xf bank_mask:0xf
    s_nop 1
    v_mfma_f32_16x16x16_bf16 v[40:43], v[50:51], v[212:213], v[40:43]
    v_mfma_f32_16x16x16_bf16 v[44:47], v[50:51], v[214:215], v[44:47]
    s_waitcnt vmcnt(5)
    s_add_u32 s50, s50, 65536
    buffer_load_dwordx4 v[240:243], v14, s[36:39], s50 offen offset:0 nt
    v_and_b32_dpp v52, v60, v4 quad_perm:[2,2,2,2] row_mask:0xf bank_mask:0xf
    v_and_b32_dpp v53, v60, v5 quad_perm:[2,2,2,2] row_mask:0xf bank_mask:0xf
    s_nop 1
    v_mfma_f32_16x16x16_bf16 v[40:43], v[52:53], v[216:217], v[40:43]
    v_mfma_f32_16x16x16_bf16 v[44:47], v[52:53], v[218:219], v[44:47]
    s_waitcnt vmcnt(5)
    buffer_load_dwordx4 v[244:247], v14, s[36:39], s50 offen offset:1024 nt
    v_and_b32_dpp v54, v60, v4 quad_perm:[3,3,3,3] row_mask:0xf bank_mask:0xf
    v_and_b32_dpp v55, v60, v5 quad_perm:[3,3,3,3] row_mask:0xf bank_mask:0xf
    s_nop 1
    v_mfma_f32_16x16x16_bf16 v[40:43], v[54:55], v[220:221], v[40:43]
    v_mfma_f32_16x16x16_bf16 v[44:47], v[54:55], v[222:223], v[44:47]
    v_fma_f32 v61, v61, s53, -v8
    v_exp_f32 v61, v61
    s_nop 0
    v_add_f32 v7, v7, v61
    v_cvt_pk_bf16_f32 v61, v61, v61
    s_waitcnt vmcnt(5)
    buffer_load_dwordx4 v[248:251], v14, s[36:39], s50 offen offset:2048 nt
    v_and_b32_dpp v48, v61, v4 quad_perm:[0,0,0,0] row_mask:0xf bank_mask:0xf
    v_and_b32_dpp v49, v61, v5 quad_perm:[0,0,0,0] row_mask:0xf bank_mask:0xf
    s_nop 1
    v_mfma_f32_16x16x16_bf16 v[40:43], v[48:49], v[224:225], v[40:43]
    v_mfma_f32_16x16x16_bf16 v[44:47], v[48:49], v[226:227], v[44:47]
    s_waitcnt vmcnt(5)
    buffer_load_dwordx4 v[252:255], v14, s[36:39], s50 offen offset:3072 nt
    v_and_b32_dpp v50, v61, v4 quad_perm:[1,1,1,1] row_mask:0xf bank_mask:0xf
    v_and_b32_dpp v51, v61, v5 quad_perm:[1,1,1,1] row_mask:0xf bank_mask:0xf
    s_nop 1
    v_mfma_f32_16x16x16_bf16 v[40:43], v[50:51], v[228:229], v[40:43]
    v_mfma_f32_16x16x16_bf16 v[44:47], v[50:51], v[230:231], v[44:47]
    s_waitcnt vmcnt(5)
    s_add_u32 s50, s50, 65536
    buffer_load_dwordx4 v[96:99], v14, s[36:39], s50 offen offset:0 nt
    v_and_b32_dpp v52, v61, v4 quad_perm:[2,2,2,2] row_mask:0xf bank_mask:0xf
    v_and_b32_dpp v53, v61, v5 quad_perm:[2,2,2,2] row_mask:0xf bank_mask:0xf
    s_nop 1
    v_mfma_f32_16x16x16_bf16 v[40:43], v[52:53], v[232:233], v[40:43]
    v_mfma_f32_16x16x16_bf16 v[44:47], v[52:53], v[234:235], v[44:47]
    s_waitcnt vmcnt(5)
    buffer_load_dwordx4 v[100:103], v14, s[36:39], s50 offen offset:1024 nt
    v_and_b32_dpp v54, v61, v4 quad_perm:[3,3,3,3] row_mask:0xf bank_mask:0xf
    v_and_b32_dpp v55, v61, v5 quad_perm:[3,3,3,3] row_mask:0xf bank_mask:0xf
    s_nop 1
    v_mfma_f32_16x16x16_bf16 v[40:43], v[54:55], v[236:237], v[40:43]
    v_mfma_f32_16x16x16_bf16 v[44:47], v[54:55], v[238:239], v[44:47]
    v_fma_f32 v62, v62, s53, -v8
    v_exp_f32 v62, v62
    s_nop 0
    v_add_f32 v7, v7, v62
    v_cvt_pk_bf16_f32 v62, v62, v62
    s_waitcnt vmcnt(5)
    buffer_load_dwordx4 v[104:107], v14, s[36:39], s50 offen offset:2048 nt
    v_and_b32_dpp v48, v62, v4 quad_perm:[0,0,0,0] row_mask:0xf bank_mask:0xf
    v_and_b32_dpp v49, v62, v5 quad_perm:[0,0,0,0] row_mask:0xf bank_mask:0xf
    s_nop 1
    v_mfma_f32_16x16x16_bf16 v[40:43], v[48:49], v[240:241], v[40:43]
    v_mfma_f32_16x16x16_bf16 v[44:47], v[48:49], v[242:243], v[44:47]
    s_waitcnt vmcnt(5)
    buffer_load_dwordx4 v[108:111], v14, s[36:39], s50 offen offset:3072 nt
    v_and_b32_dpp v50, v62, v4 quad_perm:[1,1,1,1] row_mask:0xf bank_mask:0xf
    v_and_b32_dpp v51, v62, v5 quad_perm:[1,1,1,1] row_mask:0xf bank_mask:0xf
    s_nop 1
    v_mfma_f32_16x16x16_bf16 v[40:43], v[50:51], v[244:245], v[40:43]
    v_mfma_f32_16x16x16_bf16 v[44:47], v[50:51], v[246:247], v[44:47]
    s_waitcnt vmcnt(5)
    s_add_u32 s50, s50, 65536
    buffer_load_dwordx4 v[112:115], v14, s[36:39], s50 offen offset:0 nt
    v_and_b32_dpp v52, v62, v4 quad_perm:[2,2,2,2] row_mask:0xf bank_mask:0xf
    v_and_b32_dpp v53, v62, v5 quad_perm:[2,2,2,2] row_mask:0xf bank_mask:0xf
    s_nop 1
    v_mfma_f32_16x16x16_bf16 v[40:43], v[52:53], v[248:249], v[40:43]
    v_mfma_f32_16x16x16_bf16 v[44:47], v[52:53], v[250:251], v[44:47]
    s_waitcnt vmcnt(5)
    buffer_load_dwordx4 v[116:119], v14, s[36:39], s50 offen offset:1024 nt
    v_and_b32_dpp v54, v62, v4 quad_perm:[3,3,3,3] row_mask:0xf bank_mask:0xf
    v_and_b32_dpp v55, v62, v5 quad_perm:[3,3,3,3] row_mask:0xf bank_mask:0xf
    s_nop 1
    v_mfma_f32_16x16x16_bf16 v[40:43], v[54:55], v[252:253], v[40:43]
    v_mfma_f32_16x16x16_bf16 v[44:47], v[54:55], v[254:255], v[44:47]
    v_fma_f32 v63, v63, s53, -v8
    v_exp_f32 v63, v63
    s_nop 0
    v_add_f32 v7, v7, v63
    v_cvt_pk_bf16_f32 v63, v63, v63
    s_waitcnt vmcnt(5)
    buffer_load_dwordx4 v[120:123], v14, s[36:39], s50 offen offset:2048 nt
    v_and_b32_dpp v48, v63, v4 quad_perm:[0,0,0,0] row_mask:0xf bank_mask:0xf
    v_and_b32_dpp v49, v63, v5 quad_perm:[0,0,0,0] row_mask:0xf bank_mask:0xf
    s_nop 1
    v_mfma_f32_16x16x16_bf16 v[40:43], v[48:49], v[96:97], v[40:43]
    v_mfma_f32_16x16x16_bf16 v[44:47], v[48:49], v[98:99], v[44:47]
    s_waitcnt vmcnt(5)
    buffer_load_dwordx4 v[124:127], v14, s[36:39], s50 offen offset:3072 nt
    v_and_b32_dpp v50, v63, v4 quad_perm:[1,1,1,1] row_mask:0xf bank_mask:0xf
    v_and_b32_dpp v51, v63, v5 quad_perm:[1,1,1,1] row_mask:0xf bank_mask:0xf
    s_nop 1
    v_mfma_f32_16x16x16_bf16 v[40:43], v[50:51], v[100:101], v[40:43]
    v_mfma_f32_16x16x16_bf16 v[44:47], v[50:51], v[102:103], v[44:47]
    s_waitcnt vmcnt(5)
    s_add_u32 s50, s50, 65536
    buffer_load_dwordx4 v[128:131], v14, s[36:39], s50 offen offset:0 nt
    v_and_b32_dpp v52, v63, v4 quad_perm:[2,2,2,2] row_mask:0xf bank_mask:0xf
    v_and_b32_dpp v53, v63, v5 quad_perm:[2,2,2,2] row_mask:0xf bank_mask:0xf
    s_nop 1
    v_mfma_f32_16x16x16_bf16 v[40:43], v[52:53], v[104:105], v[40:43]
    v_mfma_f32_16x16x16_bf16 v[44:47], v[52:53], v[106:107], v[44:47]
    s_waitcnt vmcnt(5)
    buffer_load_dwordx4 v[132:135], v14, s[36:39], s50 offen offset:1024 nt
    v_and_b32_dpp v54, v63, v4 quad_perm:[3,3,3,3] row_mask:0xf bank_mask:0xf
    v_and_b32_dpp v55, v63, v5 quad_perm:[3,3,3,3] row_mask:0xf bank_mask:0xf
    s_nop 1
    v_mfma_f32_16x16x16_bf16 v[40:43], v[54:55], v[108:109], v[40:43]
    v_mfma_f32_16x16x16_bf16 v[44:47], v[54:55], v[110:111], v[44:47]
    v_fma_f32 v64, v64, s53, -v8
    v_exp_f32 v64, v64
    s_nop 0
    v_add_f32 v7, v7, v64
    v_cvt_pk_bf16_f32 v64, v64, v64
    s_waitcnt vmcnt(5)
    buffer_load_dwordx4 v[136:139], v14, s[36:39], s50 offen offset:2048 nt
    v_and_b32_dpp v48, v64, v4 quad_perm:[0,0,0,0] row_mask:0xf bank_mask:0xf
    v_and_b32_dpp v49, v64, v5 quad_perm:[0,0,0,0] row_mask:0xf bank_mask:0xf
    s_nop 1
    v_mfma_f32_16x16x16_bf16 v[40:43], v[48:49], v[112:113], v[40:43]
    v_mfma_f32_16x16x16_bf16 v[44:47], v[48:49], v[114:115], v[44:47]
    s_waitcnt vmcnt(5)
    buffer_load_dwordx4 v[140:143], v14, s[36:39], s50 offen offset:3072 nt
    v_and_b32_dpp v50, v64, v4 quad_perm:[1,1,1,1] row_mask:0xf bank_mask:0xf
    v_and_b32_dpp v51, v64, v5 quad_perm:[1,1,1,1] row_mask:0xf bank_mask:0xf
    s_nop 1
    v_mfma_f32_16x16x16_bf16 v[40:43], v[50:51], v[116:117], v[40:43]
    v_mfma_f32_16x16x16_bf16 v[44:47], v[50:51], v[118:119], v[44:47]
    s_waitcnt vmcnt(5)
    s_add_u32 s50, s50, 65536
    buffer_load_dwordx4 v[144:147], v14, s[36:39], s50 offen offset:0 nt
    v_and_b32_dpp v52, v64, v4 quad_perm:[2,2,2,2] row_mask:0xf bank_mask:0xf
    v_and_b32_dpp v53, v64, v5 quad_perm:[2,2,2,2] row_mask:0xf bank_mask:0xf
    s_nop 1
    v_mfma_f32_16x16x16_bf16 v[40:43], v[52:53], v[120:121], v[40:43]
    v_mfma_f32_16x16x16_bf16 v[44:47], v[52:53], v[122:123], v[44:47]
    s_waitcnt vmcnt(5)
    buffer_load_dwordx4 v[148:151], v14, s[36:39], s50 offen offset:1024 nt
    v_and_b32_dpp v54, v64, v4 quad_perm:[3,3,3,3] row_mask:0xf bank_mask:0xf
    v_and_b32_dpp v55, v64, v5 quad_perm:[3,3,3,3] row_mask:0xf bank_mask:0xf
    s_nop 1
    v_mfma_f32_16x16x16_bf16 v[40:43], v[54:55], v[124:125], v[40:43]
    v_mfma_f32_16x16x16_bf16 v[44:47], v[54:55], v[126:127], v[44:47]
    v_fma_f32 v65, v65, s53, -v8
    v_exp_f32 v65, v65
    s_nop 0
    v_add_f32 v7, v7, v65
    v_cvt_pk_bf16_f32 v65, v65, v65
    s_waitcnt vmcnt(5)
    buffer_load_dwordx4 v[152:155], v14, s[36:39], s50 offen offset:2048 nt
    v_and_b32_dpp v48, v65, v4 quad_perm:[0,0,0,0] row_mask:0xf bank_mask:0xf
    v_and_b32_dpp v49, v65, v5 quad_perm:[0,0,0,0] row_mask:0xf bank_mask:0xf
    s_nop 1
    v_mfma_f32_16x16x16_bf16 v[40:43], v[48:49], v[128:129], v[40:43]
    v_mfma_f32_16x16x16_bf16 v[44:47], v[48:49], v[130:131], v[44:47]
    s_waitcnt vmcnt(5)
    buffer_load_dwordx4 v[156:159], v14, s[36:39], s50 offen offset:3072 nt
    v_and_b32_dpp v50, v65, v4 quad_perm:[1,1,1,1] row_mask:0xf bank_mask:0xf
    v_and_b32_dpp v51, v65, v5 quad_perm:[1,1,1,1] row_mask:0xf bank_mask:0xf
    s_nop 1
    v_mfma_f32_16x16x16_bf16 v[40:43], v[50:51], v[132:133], v[40:43]
    v_mfma_f32_16x16x16_bf16 v[44:47], v[50:51], v[134:135], v[44:47]
    s_waitcnt vmcnt(5)
    s_add_u32 s50, s50, 65536
    buffer_load_dwordx4 v[160:163], v14, s[36:39], s50 offen offset:0 nt
    v_and_b32_dpp v52, v65, v4 quad_perm:[2,2,2,2] row_mask:0xf bank_mask:0xf
    v_and_b32_dpp v53, v65, v5 quad_perm:[2,2,2,2] row_mask:0xf bank_mask:0xf
    s_nop 1
    v_mfma_f32_16x16x16_bf16 v[40:43], v[52:53], v[136:137], v[40:43]
    v_mfma_f32_16x16x16_bf16 v[44:47], v[52:53], v[138:139], v[44:47]
    s_waitcnt vmcnt(5)
    buffer_load_dwordx4 v[164:167], v14, s[36:39], s50 offen offset:1024 nt
    v_and_b32_dpp v54, v65, v4 quad_perm:[3,3,3,3] row_mask:0xf bank_mask:0xf
    v_and_b32_dpp v55, v65, v5 quad_perm:[3,3,3,3] row_mask:0xf bank_mask:0xf
    s_nop 1
    v_mfma_f32_16x16x16_bf16 v[40:43], v[54:55], v[140:141], v[40:43]
    v_mfma_f32_16x16x16_bf16 v[44:47], v[54:55], v[142:143], v[44:47]
    v_fma_f32 v66, v66, s53, -v8
    v_exp_f32 v66, v66
    s_nop 0
    v_add_f32 v7, v7, v66
    v_cvt_pk_bf16_f32 v66, v66, v66
    s_waitcnt vmcnt(5)
    buffer_load_dwordx4 v[168:171], v14, s[36:39], s50 offen offset:2048 nt
    v_and_b32_dpp v48, v66, v4 quad_perm:[0,0,0,0] row_mask:0xf bank_mask:0xf
    v_and_b32_dpp v49, v66, v5 quad_perm:[0,0,0,0] row_mask:0xf bank_mask:0xf
    s_nop 1
    v_mfma_f32_16x16x16_bf16 v[40:43], v[48:49], v[144:145], v[40:43]
    v_mfma_f32_16x16x16_bf16 v[44:47], v[48:49], v[146:147], v[44:47]
    s_waitcnt vmcnt(5)
    buffer_load_dwordx4 v[172:175], v14, s[36:39], s50 offen offset:3072 nt
    v_and_b32_dpp v50, v66, v4 quad_perm:[1,1,1,1] row_mask:0xf bank_mask:0xf
    v_and_b32_dpp v51, v66, v5 quad_perm:[1,1,1,1] row_mask:0xf bank_mask:0xf
    s_nop 1
    v_mfma_f32_16x16x16_bf16 v[40:43], v[50:51], v[148:149], v[40:43]
    v_mfma_f32_16x16x16_bf16 v[44:47], v[50:51], v[150:151], v[44:47]
    s_waitcnt vmcnt(5)
    s_add_u32 s50, s50, 65536
    buffer_load_dwordx4 v[176:179], v14, s[36:39], s50 offen offset:0 nt
    v_and_b32_dpp v52, v66, v4 quad_perm:[2,2,2,2] row_mask:0xf bank_mask:0xf
    v_and_b32_dpp v53, v66, v5 quad_perm:[2,2,2,2] row_mask:0xf bank_mask:0xf
    s_nop 1
    v_mfma_f32_16x16x16_bf16 v[40:43], v[52:53], v[152:153], v[40:43]
    v_mfma_f32_16x16x16_bf16 v[44:47], v[52:53], v[154:155], v[44:47]
    s_waitcnt vmcnt(5)
    buffer_load_dwordx4 v[180:183], v14, s[36:39], s50 offen offset:1024 nt
    v_and_b32_dpp v54, v66, v4 quad_perm:[3,3,3,3] row_mask:0xf bank_mask:0xf
    v_and_b32_dpp v55, v66, v5 quad_perm:[3,3,3,3] row_mask:0xf bank_mask:0xf
    s_nop 1
    v_mfma_f32_16x16x16_bf16 v[40:43], v[54:55], v[156:157], v[40:43]
    v_mfma_f32_16x16x16_bf16 v[44:47], v[54:55], v[158:159], v[44:47]
    v_fma_f32 v67, v67, s53, -v8
    v_exp_f32 v67, v67
    s_nop 0
    v_add_f32 v7, v7, v67
    v_cvt_pk_bf16_f32 v67, v67, v67
    s_waitcnt vmcnt(5)
    buffer_load_dwordx4 v[184:187], v14, s[36:39], s50 offen offset:2048 nt
    v_and_b32_dpp v48, v67, v4 quad_perm:[0,0,0,0] row_mask:0xf bank_mask:0xf
    v_and_b32_dpp v49, v67, v5 quad_perm:[0,0,0,0] row_mask:0xf bank_mask:0xf
    s_nop 1
    v_mfma_f32_16x16x16_bf16 v[40:43], v[48:49], v[160:161], v[40:43]
    v_mfma_f32_16x16x16_bf16 v[44:47], v[48:49], v[162:163], v[44:47]
    s_waitcnt vmcnt(5)
    buffer_load_dwordx4 v[188:191], v14, s[36:39], s50 offen offset:3072 nt
    v_and_b32_dpp v50, v67, v4 quad_perm:[1,1,1,1] row_mask:0xf bank_mask:0xf
    v_and_b32_dpp v51, v67, v5 quad_perm:[1,1,1,1] row_mask:0xf bank_mask:0xf
    s_nop 1
    v_mfma_f32_16x16x16_bf16 v[40:43], v[50:51], v[164:165], v[40:43]
    v_mfma_f32_16x16x16_bf16 v[44:47], v[50:51], v[166:167], v[44:47]
    s_waitcnt vmcnt(5)
    s_add_u32 s50, s50, 65536
    buffer_load_dwordx4 v[192:195], v14, s[36:39], s50 offen offset:0 nt
    v_and_b32_dpp v52, v67, v4 quad_perm:[2,2,2,2] row_mask:0xf bank_mask:0xf
    v_and_b32_dpp v53, v67, v5 quad_perm:[2,2,2,2] row_mask:0xf bank_mask:0xf
    s_nop 1
    v_mfma_f32_16x16x16_bf16 v[40:43], v[52:53], v[168:169], v[40:43]
    v_mfma_f32_16x16x16_bf16 v[44:47], v[52:53], v[170:171], v[44:47]
    s_waitcnt vmcnt(5)
    buffer_load_dwordx4 v[196:199], v14, s[36:39], s50 offen offset:1024 nt
    v_and_b32_dpp v54, v67, v4 quad_perm:[3,3,3,3] row_mask:0xf bank_mask:0xf
    v_and_b32_dpp v55, v67, v5 quad_perm:[3,3,3,3] row_mask:0xf bank_mask:0xf
    s_nop 1
    v_mfma_f32_16x16x16_bf16 v[40:43], v[54:55], v[172:173], v[40:43]
    v_mfma_f32_16x16x16_bf16 v[44:47], v[54:55], v[174:175], v[44:47]
    v_fma_f32 v68, v68, s53, -v8
    v_exp_f32 v68, v68
    s_nop 0
    v_add_f32 v7, v7, v68
    v_cvt_pk_bf16_f32 v68, v68, v68
    s_waitcnt vmcnt(5)
    buffer_load_dwordx4 v[200:203], v14, s[36:39], s50 offen offset:2048 nt
    v_and_b32_dpp v48, v68, v4 quad_perm:[0,0,0,0] row_mask:0xf bank_mask:0xf
    v_and_b32_dpp v49, v68, v5 quad_perm:[0,0,0,0] row_mask:0xf bank_mask:0xf
    s_nop 1
    v_mfma_f32_16x16x16_bf16 v[40:43], v[48:49], v[176:177], v[40:43]
    v_mfma_f32_16x16x16_bf16 v[44:47], v[48:49], v[178:179], v[44:47]
    s_waitcnt vmcnt(5)
    buffer_load_dwordx4 v[204:207], v14, s[36:39], s50 offen offset:3072 nt
    v_and_b32_dpp v50, v68, v4 quad_perm:[1,1,1,1] row_mask:0xf bank_mask:0xf
    v_and_b32_dpp v51, v68, v5 quad_perm:[1,1,1,1] row_mask:0xf bank_mask:0xf
    s_nop 1
    v_mfma_f32_16x16x16_bf16 v[40:43], v[50:51], v[180:181], v[40:43]
    v_mfma_f32_16x16x16_bf16 v[44:47], v[50:51], v[182:183], v[44:47]
    s_waitcnt vmcnt(5)
    s_add_u32 s50, s50, 65536
    buffer_load_dwordx4 v[208:211], v14, s[36:39], s50 offen offset:0 nt
    v_and_b32_dpp v52, v68, v4 quad_perm:[2,2,2,2] row_mask:0xf bank_mask:0xf
    v_and_b32_dpp v53, v68, v5 quad_perm:[2,2,2,2] row_mask:0xf bank_mask:0xf
    s_nop 1
    v_mfma_f32_16x16x16_bf16 v[40:43], v[52:53], v[184:185], v[40:43]
    v_mfma_f32_16x16x16_bf16 v[44:47], v[52:53], v[186:187], v[44:47]
    s_waitcnt vmcnt(5)
    buffer_load_dwordx4 v[212:215], v14, s[36:39], s50 offen offset:1024 nt
    v_and_b32_dpp v54, v68, v4 quad_perm:[3,3,3,3] row_mask:0xf bank_mask:0xf
    v_and_b32_dpp v55, v68, v5 quad_perm:[3,3,3,3] row_mask:0xf bank_mask:0xf
    s_nop 1
    v_mfma_f32_16x16x16_bf16 v[40:43], v[54:55], v[188:189], v[40:43]
    v_mfma_f32_16x16x16_bf16 v[44:47], v[54:55], v[190:191], v[44:47]
    v_fma_f32 v69, v69, s53, -v8
    v_exp_f32 v69, v69
    s_nop 0
    v_add_f32 v7, v7, v69
    v_cvt_pk_bf16_f32 v69, v69, v69
    s_waitcnt vmcnt(5)
    buffer_load_dwordx4 v[216:219], v14, s[36:39], s50 offen offset:2048 nt
    v_and_b32_dpp v48, v69, v4 quad_perm:[0,0,0,0] row_mask:0xf bank_mask:0xf
    v_and_b32_dpp v49, v69, v5 quad_perm:[0,0,0,0] row_mask:0xf bank_mask:0xf
    s_nop 1
    v_mfma_f32_16x16x16_bf16 v[40:43], v[48:49], v[192:193], v[40:43]
    v_mfma_f32_16x16x16_bf16 v[44:47], v[48:49], v[194:195], v[44:47]
    s_waitcnt vmcnt(5)
    buffer_load_dwordx4 v[220:223], v14, s[36:39], s50 offen offset:3072 nt
    v_and_b32_dpp v50, v69, v4 quad_perm:[1,1,1,1] row_mask:0xf bank_mask:0xf
    v_and_b32_dpp v51, v69, v5 quad_perm:[1,1,1,1] row_mask:0xf bank_mask:0xf
    s_nop 1
    v_mfma_f32_16x16x16_bf16 v[40:43], v[50:51], v[196:197], v[40:43]
    v_mfma_f32_16x16x16_bf16 v[44:47], v[50:51], v[198:199], v[44:47]
    s_waitcnt vmcnt(5)
    s_add_u32 s50, s50, 65536
    buffer_load_dwordx4 v[224:227], v14, s[36:39], s50 offen offset:0 nt
    v_and_b32_dpp v52, v69, v4 quad_perm:[2,2,2,2] row_mask:0xf bank_mask:0xf
    v_and_b32_dpp v53, v69, v5 quad_perm:[2,2,2,2] row_mask:0xf bank_mask:0xf
    s_nop 1
    v_mfma_f32_16x16x16_bf16 v[40:43], v[52:53], v[200:201], v[40:43]
    v_mfma_f32_16x16x16_bf16 v[44:47], v[52:53], v[202:203], v[44:47]
    s_waitcnt vmcnt(5)
    buffer_load_dwordx4 v[228:231], v14, s[36:39], s50 offen offset:1024 nt
    v_and_b32_dpp v54, v69, v4 quad_perm:[3,3,3,3] row_mask:0xf bank_mask:0xf
    v_and_b32_dpp v55, v69, v5 quad_perm:[3,3,3,3] row_mask:0xf bank_mask:0xf
    s_nop 1
    v_mfma_f32_16x16x16_bf16 v[40:43], v[54:55], v[204:205], v[40:43]
    v_mfma_f32_16x16x16_bf16 v[44:47], v[54:55], v[206:207], v[44:47]
    v_fma_f32 v70, v70, s53, -v8
    v_exp_f32 v70, v70
    s_nop 0
    v_add_f32 v7, v7, v70
    v_cvt_pk_bf16_f32 v70, v70, v70
    s_waitcnt vmcnt(5)
    buffer_load_dwordx4 v[232:235], v14, s[36:39], s50 offen offset:2048 nt
    v_and_b32_dpp v48, v70, v4 quad_perm:[0,0,0,0] row_mask:0xf bank_mask:0xf
    v_and_b32_dpp v49, v70, v5 quad_perm:[0,0,0,0] row_mask:0xf bank_mask:0xf
    s_nop 1
    v_mfma_f32_16x16x16_bf16 v[40:43], v[48:49], v[208:209], v[40:43]
    v_mfma_f32_16x16x16_bf16 v[44:47], v[48:49], v[210:211], v[44:47]
    s_waitcnt vmcnt(5)
    buffer_load_dwordx4 v[236:239], v14, s[36:39], s50 offen offset:3072 nt
    v_and_b32_dpp v50, v70, v4 quad_perm:[1,1,1,1] row_mask:0xf bank_mask:0xf
    v_and_b32_dpp v51, v70, v5 quad_perm:[1,1,1,1] row_mask:0xf bank_mask:0xf
    s_nop 1
    v_mfma_f32_16x16x16_bf16 v[40:43], v[50:51], v[212:213], v[40:43]
    v_mfma_f32_16x16x16_bf16 v[44:47], v[50:51], v[214:215], v[44:47]
    s_waitcnt vmcnt(5)
    s_add_u32 s50, s50, 65536
    buffer_load_dwordx4 v[240:243], v14, s[36:39], s50 offen offset:0 nt
    v_and_b32_dpp v52, v70, v4 quad_perm:[2,2,2,2] row_mask:0xf bank_mask:0xf
    v_and_b32_dpp v53, v70, v5 quad_perm:[2,2,2,2] row_mask:0xf bank_mask:0xf
    s_nop 1
    v_mfma_f32_16x16x16_bf16 v[40:43], v[52:53], v[216:217], v[40:43]
    v_mfma_f32_16x16x16_bf16 v[44:47], v[52:53], v[218:219], v[44:47]
    s_waitcnt vmcnt(5)
    buffer_load_dwordx4 v[244:247], v14, s[36:39], s50 offen offset:1024 nt
    v_and_b32_dpp v54, v70, v4 quad_perm:[3,3,3,3] row_mask:0xf bank_mask:0xf
    v_and_b32_dpp v55, v70, v5 quad_perm:[3,3,3,3] row_mask:0xf bank_mask:0xf
    s_nop 1
    v_mfma_f32_16x16x16_bf16 v[40:43], v[54:55], v[220:221], v[40:43]
    v_mfma_f32_16x16x16_bf16 v[44:47], v[54:55], v[222:223], v[44:47]
    v_fma_f32 v71, v71, s53, -v8
    v_exp_f32 v71, v71
    s_nop 0
    v_add_f32 v7, v7, v71
    v_cvt_pk_bf16_f32 v71, v71, v71
    s_waitcnt vmcnt(5)
    buffer_load_dwordx4 v[248:251], v14, s[36:39], s50 offen offset:2048 nt
    v_and_b32_dpp v48, v71, v4 quad_perm:[0,0,0,0] row_mask:0xf bank_mask:0xf
    v_and_b32_dpp v49, v71, v5 quad_perm:[0,0,0,0] row_mask:0xf bank_mask:0xf
    s_nop 1
    v_mfma_f32_16x16x16_bf16 v[40:43], v[48:49], v[224:225], v[40:43]
    v_mfma_f32_16x16x16_bf16 v[44:47], v[48:49], v[226:227], v[44:47]
    s_waitcnt vmcnt(5)
    buffer_load_dwordx4 v[252:255], v14, s[36:39], s50 offen offset:3072 nt
    v_and_b32_dpp v50, v71, v4 quad_perm:[1,1,1,1] row_mask:0xf bank_mask:0xf
    v_and_b32_dpp v51, v71, v5 quad_perm:[1,1,1,1] row_mask:0xf bank_mask:0xf
    s_nop 1
    v_mfma_f32_16x16x16_bf16 v[40:43], v[50:51], v[228:229], v[40:43]
    v_mfma_f32_16x16x16_bf16 v[44:47], v[50:51], v[230:231], v[44:47]
    s_waitcnt vmcnt(5)
    s_add_u32 s50, s50, 65536
    buffer_load_dwordx4 v[96:99], v14, s[36:39], s50 offen offset:0 nt
    v_and_b32_dpp v52, v71, v4 quad_perm:[2,2,2,2] row_mask:0xf bank_mask:0xf
    v_and_b32_dpp v53, v71, v5 quad_perm:[2,2,2,2] row_mask:0xf bank_mask:0xf
    s_nop 1
    v_mfma_f32_16x16x16_bf16 v[40:43], v[52:53], v[232:233], v[40:43]
    v_mfma_f32_16x16x16_bf16 v[44:47], v[52:53], v[234:235], v[44:47]
    s_waitcnt vmcnt(5)
    buffer_load_dwordx4 v[100:103], v14, s[36:39], s50 offen offset:1024 nt
    v_and_b32_dpp v54, v71, v4 quad_perm:[3,3,3,3] row_mask:0xf bank_mask:0xf
    v_and_b32_dpp v55, v71, v5 quad_perm:[3,3,3,3] row_mask:0xf bank_mask:0xf
    s_nop 1
    v_mfma_f32_16x16x16_bf16 v[40:43], v[54:55], v[236:237], v[40:43]
    v_mfma_f32_16x16x16_bf16 v[44:47], v[54:55], v[238:239], v[44:47]
    v_fma_f32 v72, v72, s53, -v8
    v_exp_f32 v72, v72
    s_nop 0
    v_add_f32 v7, v7, v72
    v_cvt_pk_bf16_f32 v72, v72, v72
    s_waitcnt vmcnt(5)
    buffer_load_dwordx4 v[104:107], v14, s[36:39], s50 offen offset:2048 nt
    v_and_b32_dpp v48, v72, v4 quad_perm:[0,0,0,0] row_mask:0xf bank_mask:0xf
    v_and_b32_dpp v49, v72, v5 quad_perm:[0,0,0,0] row_mask:0xf bank_mask:0xf
    s_nop 1
    v_mfma_f32_16x16x16_bf16 v[40:43], v[48:49], v[240:241], v[40:43]
    v_mfma_f32_16x16x16_bf16 v[44:47], v[48:49], v[242:243], v[44:47]
    s_waitcnt vmcnt(5)
    buffer_load_dwordx4 v[108:111], v14, s[36:39], s50 offen offset:3072 nt
    v_and_b32_dpp v50, v72, v4 quad_perm:[1,1,1,1] row_mask:0xf bank_mask:0xf
    v_and_b32_dpp v51, v72, v5 quad_perm:[1,1,1,1] row_mask:0xf bank_mask:0xf
    s_nop 1
    v_mfma_f32_16x16x16_bf16 v[40:43], v[50:51], v[244:245], v[40:43]
    v_mfma_f32_16x16x16_bf16 v[44:47], v[50:51], v[246:247], v[44:47]
    s_waitcnt vmcnt(5)
    s_add_u32 s50, s50, 65536
    buffer_load_dwordx4 v[112:115], v14, s[36:39], s50 offen offset:0 nt
    v_and_b32_dpp v52, v72, v4 quad_perm:[2,2,2,2] row_mask:0xf bank_mask:0xf
    v_and_b32_dpp v53, v72, v5 quad_perm:[2,2,2,2] row_mask:0xf bank_mask:0xf
    s_nop 1
    v_mfma_f32_16x16x16_bf16 v[40:43], v[52:53], v[248:249], v[40:43]
    v_mfma_f32_16x16x16_bf16 v[44:47], v[52:53], v[250:251], v[44:47]
    s_waitcnt vmcnt(5)
    buffer_load_dwordx4 v[116:119], v14, s[36:39], s50 offen offset:1024 nt
    v_and_b32_dpp v54, v72, v4 quad_perm:[3,3,3,3] row_mask:0xf bank_mask:0xf
    v_and_b32_dpp v55, v72, v5 quad_perm:[3,3,3,3] row_mask:0xf bank_mask:0xf
    s_nop 1
    v_mfma_f32_16x16x16_bf16 v[40:43], v[54:55], v[252:253], v[40:43]
    v_mfma_f32_16x16x16_bf16 v[44:47], v[54:55], v[254:255], v[44:47]
    v_fma_f32 v73, v73, s53, -v8
    v_exp_f32 v73, v73
    s_nop 0
    v_add_f32 v7, v7, v73
    v_cvt_pk_bf16_f32 v73, v73, v73
    s_waitcnt vmcnt(5)
    buffer_load_dwordx4 v[120:123], v14, s[36:39], s50 offen offset:2048 nt
    v_and_b32_dpp v48, v73, v4 quad_perm:[0,0,0,0] row_mask:0xf bank_mask:0xf
    v_and_b32_dpp v49, v73, v5 quad_perm:[0,0,0,0] row_mask:0xf bank_mask:0xf
    s_nop 1
    v_mfma_f32_16x16x16_bf16 v[40:43], v[48:49], v[96:97], v[40:43]
    v_mfma_f32_16x16x16_bf16 v[44:47], v[48:49], v[98:99], v[44:47]
    s_waitcnt vmcnt(5)
    buffer_load_dwordx4 v[124:127], v14, s[36:39], s50 offen offset:3072 nt
    v_and_b32_dpp v50, v73, v4 quad_perm:[1,1,1,1] row_mask:0xf bank_mask:0xf
    v_and_b32_dpp v51, v73, v5 quad_perm:[1,1,1,1] row_mask:0xf bank_mask:0xf
    s_nop 1
    v_mfma_f32_16x16x16_bf16 v[40:43], v[50:51], v[100:101], v[40:43]
    v_mfma_f32_16x16x16_bf16 v[44:47], v[50:51], v[102:103], v[44:47]
    s_waitcnt vmcnt(5)
    s_add_u32 s50, s50, 65536
    buffer_load_dwordx4 v[128:131], v14, s[36:39], s50 offen offset:0 nt
    v_and_b32_dpp v52, v73, v4 quad_perm:[2,2,2,2] row_mask:0xf bank_mask:0xf
    v_and_b32_dpp v53, v73, v5 quad_perm:[2,2,2,2] row_mask:0xf bank_mask:0xf
    s_nop 1
    v_mfma_f32_16x16x16_bf16 v[40:43], v[52:53], v[104:105], v[40:43]
    v_mfma_f32_16x16x16_bf16 v[44:47], v[52:53], v[106:107], v[44:47]
    s_waitcnt vmcnt(5)
    buffer_load_dwordx4 v[132:135], v14, s[36:39], s50 offen offset:1024 nt
    v_and_b32_dpp v54, v73, v4 quad_perm:[3,3,3,3] row_mask:0xf bank_mask:0xf
    v_and_b32_dpp v55, v73, v5 quad_perm:[3,3,3,3] row_mask:0xf bank_mask:0xf
    s_nop 1
    v_mfma_f32_16x16x16_bf16 v[40:43], v[54:55], v[108:109], v[40:43]
    v_mfma_f32_16x16x16_bf16 v[44:47], v[54:55], v[110:111], v[44:47]
    v_fma_f32 v74, v74, s53, -v8
    v_exp_f32 v74, v74
    s_nop 0
    v_add_f32 v7, v7, v74
    v_cvt_pk_bf16_f32 v74, v74, v74
    s_waitcnt vmcnt(5)
    buffer_load_dwordx4 v[136:139], v14, s[36:39], s50 offen offset:2048 nt
    v_and_b32_dpp v48, v74, v4 quad_perm:[0,0,0,0] row_mask:0xf bank_mask:0xf
    v_and_b32_dpp v49, v74, v5 quad_perm:[0,0,0,0] row_mask:0xf bank_mask:0xf
    s_nop 1
    v_mfma_f32_16x16x16_bf16 v[40:43], v[48:49], v[112:113], v[40:43]
    v_mfma_f32_16x16x16_bf16 v[44:47], v[48:49], v[114:115], v[44:47]
    s_waitcnt vmcnt(5)
    buffer_load_dwordx4 v[140:143], v14, s[36:39], s50 offen offset:3072 nt
    v_and_b32_dpp v50, v74, v4 quad_perm:[1,1,1,1] row_mask:0xf bank_mask:0xf
    v_and_b32_dpp v51, v74, v5 quad_perm:[1,1,1,1] row_mask:0xf bank_mask:0xf
    s_nop 1
    v_mfma_f32_16x16x16_bf16 v[40:43], v[50:51], v[116:117], v[40:43]
    v_mfma_f32_16x16x16_bf16 v[44:47], v[50:51], v[118:119], v[44:47]
    s_waitcnt vmcnt(5)
    s_add_u32 s50, s50, 65536
    buffer_load_dwordx4 v[144:147], v14, s[36:39], s50 offen offset:0 nt
    v_and_b32_dpp v52, v74, v4 quad_perm:[2,2,2,2] row_mask:0xf bank_mask:0xf
    v_and_b32_dpp v53, v74, v5 quad_perm:[2,2,2,2] row_mask:0xf bank_mask:0xf
    s_nop 1
    v_mfma_f32_16x16x16_bf16 v[40:43], v[52:53], v[120:121], v[40:43]
    v_mfma_f32_16x16x16_bf16 v[44:47], v[52:53], v[122:123], v[44:47]
    s_waitcnt vmcnt(5)
    buffer_load_dwordx4 v[148:151], v14, s[36:39], s50 offen offset:1024 nt
    v_and_b32_dpp v54, v74, v4 quad_perm:[3,3,3,3] row_mask:0xf bank_mask:0xf
    v_and_b32_dpp v55, v74, v5 quad_perm:[3,3,3,3] row_mask:0xf bank_mask:0xf
    s_nop 1
    v_mfma_f32_16x16x16_bf16 v[40:43], v[54:55], v[124:125], v[40:43]
    v_mfma_f32_16x16x16_bf16 v[44:47], v[54:55], v[126:127], v[44:47]
    v_fma_f32 v75, v75, s53, -v8
    v_exp_f32 v75, v75
    s_nop 0
    v_add_f32 v7, v7, v75
    v_cvt_pk_bf16_f32 v75, v75, v75
    s_waitcnt vmcnt(5)
    buffer_load_dwordx4 v[152:155], v14, s[36:39], s50 offen offset:2048 nt
    v_and_b32_dpp v48, v75, v4 quad_perm:[0,0,0,0] row_mask:0xf bank_mask:0xf
    v_and_b32_dpp v49, v75, v5 quad_perm:[0,0,0,0] row_mask:0xf bank_mask:0xf
    s_nop 1
    v_mfma_f32_16x16x16_bf16 v[40:43], v[48:49], v[128:129], v[40:43]
    v_mfma_f32_16x16x16_bf16 v[44:47], v[48:49], v[130:131], v[44:47]
    s_waitcnt vmcnt(5)
    buffer_load_dwordx4 v[156:159], v14, s[36:39], s50 offen offset:3072 nt
    v_and_b32_dpp v50, v75, v4 quad_perm:[1,1,1,1] row_mask:0xf bank_mask:0xf
    v_and_b32_dpp v51, v75, v5 quad_perm:[1,1,1,1] row_mask:0xf bank_mask:0xf
    s_nop 1
    v_mfma_f32_16x16x16_bf16 v[40:43], v[50:51], v[132:133], v[40:43]
    v_mfma_f32_16x16x16_bf16 v[44:47], v[50:51], v[134:135], v[44:47]
    s_waitcnt vmcnt(5)
    s_add_u32 s50, s50, 65536
    buffer_load_dwordx4 v[160:163], v14, s[36:39], s50 offen offset:0 nt
    v_and_b32_dpp v52, v75, v4 quad_perm:[2,2,2,2] row_mask:0xf bank_mask:0xf
    v_and_b32_dpp v53, v75, v5 quad_perm:[2,2,2,2] row_mask:0xf bank_mask:0xf
    s_nop 1
    v_mfma_f32_16x16x16_bf16 v[40:43], v[52:53], v[136:137], v[40:43]
    v_mfma_f32_16x16x16_bf16 v[44:47], v[52:53], v[138:139], v[44:47]
    s_waitcnt vmcnt(5)
    buffer_load_dwordx4 v[164:167], v14, s[36:39], s50 offen offset:1024 nt
    v_and_b32_dpp v54, v75, v4 quad_perm:[3,3,3,3] row_mask:0xf bank_mask:0xf
    v_and_b32_dpp v55, v75, v5 quad_perm:[3,3,3,3] row_mask:0xf bank_mask:0xf
    s_nop 1
    v_mfma_f32_16x16x16_bf16 v[40:43], v[54:55], v[140:141], v[40:43]
    v_mfma_f32_16x16x16_bf16 v[44:47], v[54:55], v[142:143], v[44:47]
    v_fma_f32 v76, v76, s53, -v8
    v_exp_f32 v76, v76
    s_nop 0
    v_add_f32 v7, v7, v76
    v_cvt_pk_bf16_f32 v76, v76, v76
    s_waitcnt vmcnt(5)
    buffer_load_dwordx4 v[168:171], v14, s[36:39], s50 offen offset:2048 nt
    v_and_b32_dpp v48, v76, v4 quad_perm:[0,0,0,0] row_mask:0xf bank_mask:0xf
    v_and_b32_dpp v49, v76, v5 quad_perm:[0,0,0,0] row_mask:0xf bank_mask:0xf
    s_nop 1
    v_mfma_f32_16x16x16_bf16 v[40:43], v[48:49], v[144:145], v[40:43]
    v_mfma_f32_16x16x16_bf16 v[44:47], v[48:49], v[146:147], v[44:47]
    s_waitcnt vmcnt(5)
    buffer_load_dwordx4 v[172:175], v14, s[36:39], s50 offen offset:3072 nt
    v_and_b32_dpp v50, v76, v4 quad_perm:[1,1,1,1] row_mask:0xf bank_mask:0xf
    v_and_b32_dpp v51, v76, v5 quad_perm:[1,1,1,1] row_mask:0xf bank_mask:0xf
    s_nop 1
    v_mfma_f32_16x16x16_bf16 v[40:43], v[50:51], v[148:149], v[40:43]
    v_mfma_f32_16x16x16_bf16 v[44:47], v[50:51], v[150:151], v[44:47]
    s_waitcnt vmcnt(5)
    s_add_u32 s50, s50, 65536
    buffer_load_dwordx4 v[176:179], v14, s[36:39], s50 offen offset:0 nt
    v_and_b32_dpp v52, v76, v4 quad_perm:[2,2,2,2] row_mask:0xf bank_mask:0xf
    v_and_b32_dpp v53, v76, v5 quad_perm:[2,2,2,2] row_mask:0xf bank_mask:0xf
    s_nop 1
    v_mfma_f32_16x16x16_bf16 v[40:43], v[52:53], v[152:153], v[40:43]
    v_mfma_f32_16x16x16_bf16 v[44:47], v[52:53], v[154:155], v[44:47]
    s_waitcnt vmcnt(5)
    buffer_load_dwordx4 v[180:183], v14, s[36:39], s50 offen offset:1024 nt
    v_and_b32_dpp v54, v76, v4 quad_perm:[3,3,3,3] row_mask:0xf bank_mask:0xf
    v_and_b32_dpp v55, v76, v5 quad_perm:[3,3,3,3] row_mask:0xf bank_mask:0xf
    s_nop 1
    v_mfma_f32_16x16x16_bf16 v[40:43], v[54:55], v[156:157], v[40:43]
    v_mfma_f32_16x16x16_bf16 v[44:47], v[54:55], v[158:159], v[44:47]
    v_fma_f32 v77, v77, s53, -v8
    v_exp_f32 v77, v77
    s_nop 0
    v_add_f32 v7, v7, v77
    v_cvt_pk_bf16_f32 v77, v77, v77
    s_waitcnt vmcnt(5)
    buffer_load_dwordx4 v[184:187], v14, s[36:39], s50 offen offset:2048 nt
    v_and_b32_dpp v48, v77, v4 quad_perm:[0,0,0,0] row_mask:0xf bank_mask:0xf
    v_and_b32_dpp v49, v77, v5 quad_perm:[0,0,0,0] row_mask:0xf bank_mask:0xf
    s_nop 1
    v_mfma_f32_16x16x16_bf16 v[40:43], v[48:49], v[160:161], v[40:43]
    v_mfma_f32_16x16x16_bf16 v[44:47], v[48:49], v[162:163], v[44:47]
    s_waitcnt vmcnt(5)
    buffer_load_dwordx4 v[188:191], v14, s[36:39], s50 offen offset:3072 nt
    v_and_b32_dpp v50, v77, v4 quad_perm:[1,1,1,1] row_mask:0xf bank_mask:0xf
    v_and_b32_dpp v51, v77, v5 quad_perm:[1,1,1,1] row_mask:0xf bank_mask:0xf
    s_nop 1
    v_mfma_f32_16x16x16_bf16 v[40:43], v[50:51], v[164:165], v[40:43]
    v_mfma_f32_16x16x16_bf16 v[44:47], v[50:51], v[166:167], v[44:47]
    s_waitcnt vmcnt(5)
    s_add_u32 s50, s50, 65536
    buffer_load_dwordx4 v[192:195], v14, s[36:39], s50 offen offset:0 nt
    v_and_b32_dpp v52, v77, v4 quad_perm:[2,2,2,2] row_mask:0xf bank_mask:0xf
    v_and_b32_dpp v53, v77, v5 quad_perm:[2,2,2,2] row_mask:0xf bank_mask:0xf
    s_nop 1
    v_mfma_f32_16x16x16_bf16 v[40:43], v[52:53], v[168:169], v[40:43]
    v_mfma_f32_16x16x16_bf16 v[44:47], v[52:53], v[170:171], v[44:47]
    s_waitcnt vmcnt(5)
    buffer_load_dwordx4 v[196:199], v14, s[36:39], s50 offen offset:1024 nt
    v_and_b32_dpp v54, v77, v4 quad_perm:[3,3,3,3] row_mask:0xf bank_mask:0xf
    v_and_b32_dpp v55, v77, v5 quad_perm:[3,3,3,3] row_mask:0xf bank_mask:0xf
    s_nop 1
    v_mfma_f32_16x16x16_bf16 v[40:43], v[54:55], v[172:173], v[40:43]
    v_mfma_f32_16x16x16_bf16 v[44:47], v[54:55], v[174:175], v[44:47]
    v_fma_f32 v78, v78, s53, -v8
    v_exp_f32 v78, v78
    s_nop 0
    v_add_f32 v7, v7, v78
    v_cvt_pk_bf16_f32 v78, v78, v78
    s_waitcnt vmcnt(5)
    buffer_load_dwordx4 v[200:203], v14, s[36:39], s50 offen offset:2048 nt
    v_and_b32_dpp v48, v78, v4 quad_perm:[0,0,0,0] row_mask:0xf bank_mask:0xf
    v_and_b32_dpp v49, v78, v5 quad_perm:[0,0,0,0] row_mask:0xf bank_mask:0xf
    s_nop 1
    v_mfma_f32_16x16x16_bf16 v[40:43], v[48:49], v[176:177], v[40:43]
    v_mfma_f32_16x16x16_bf16 v[44:47], v[48:49], v[178:179], v[44:47]
    s_waitcnt vmcnt(5)
    buffer_load_dwordx4 v[204:207], v14, s[36:39], s50 offen offset:3072 nt
    v_and_b32_dpp v50, v78, v4 quad_perm:[1,1,1,1] row_mask:0xf bank_mask:0xf
    v_and_b32_dpp v51, v78, v5 quad_perm:[1,1,1,1] row_mask:0xf bank_mask:0xf
    s_nop 1
    v_mfma_f32_16x16x16_bf16 v[40:43], v[50:51], v[180:181], v[40:43]
    v_mfma_f32_16x16x16_bf16 v[44:47], v[50:51], v[182:183], v[44:47]
    s_waitcnt vmcnt(5)
    s_add_u32 s50, s50, 65536
    buffer_load_dwordx4 v[208:211], v14, s[36:39], s50 offen offset:0 nt
    v_and_b32_dpp v52, v78, v4 quad_perm:[2,2,2,2] row_mask:0xf bank_mask:0xf
    v_and_b32_dpp v53, v78, v5 quad_perm:[2,2,2,2] row_mask:0xf bank_mask:0xf
    s_nop 1
    v_mfma_f32_16x16x16_bf16 v[40:43], v[52:53], v[184:185], v[40:43]
    v_mfma_f32_16x16x16_bf16 v[44:47], v[52:53], v[186:187], v[44:47]
    s_waitcnt vmcnt(5)
    buffer_load_dwordx4 v[212:215], v14, s[36:39], s50 offen offset:1024 nt
    v_and_b32_dpp v54, v78, v4 quad_perm:[3,3,3,3] row_mask:0xf bank_mask:0xf
    v_and_b32_dpp v55, v78, v5 quad_perm:[3,3,3,3] row_mask:0xf bank_mask:0xf
    s_nop 1
    v_mfma_f32_16x16x16_bf16 v[40:43], v[54:55], v[188:189], v[40:43]
    v_mfma_f32_16x16x16_bf16 v[44:47], v[54:55], v[190:191], v[44:47]
    v_fma_f32 v79, v79, s53, -v8
    v_exp_f32 v79, v79
    s_nop 0
    v_add_f32 v7, v7, v79
    v_cvt_pk_bf16_f32 v79, v79, v79
    s_waitcnt vmcnt(5)
    buffer_load_dwordx4 v[216:219], v14, s[36:39], s50 offen offset:2048 nt
    v_and_b32_dpp v48, v79, v4 quad_perm:[0,0,0,0] row_mask:0xf bank_mask:0xf
    v_and_b32_dpp v49, v79, v5 quad_perm:[0,0,0,0] row_mask:0xf bank_mask:0xf
    s_nop 1
    v_mfma_f32_16x16x16_bf16 v[40:43], v[48:49], v[192:193], v[40:43]
    v_mfma_f32_16x16x16_bf16 v[44:47], v[48:49], v[194:195], v[44:47]
    s_waitcnt vmcnt(5)
    buffer_load_dwordx4 v[220:223], v14, s[36:39], s50 offen offset:3072 nt
    v_and_b32_dpp v50, v79, v4 quad_perm:[1,1,1,1] row_mask:0xf bank_mask:0xf
    v_and_b32_dpp v51, v79, v5 quad_perm:[1,1,1,1] row_mask:0xf bank_mask:0xf
    s_nop 1
    v_mfma_f32_16x16x16_bf16 v[40:43], v[50:51], v[196:197], v[40:43]
    v_mfma_f32_16x16x16_bf16 v[44:47], v[50:51], v[198:199], v[44:47]
    s_waitcnt vmcnt(5)
    s_add_u32 s50, s50, 65536
    buffer_load_dwordx4 v[224:227], v14, s[36:39], s50 offen offset:0 nt
    v_and_b32_dpp v52, v79, v4 quad_perm:[2,2,2,2] row_mask:0xf bank_mask:0xf
    v_and_b32_dpp v53, v79, v5 quad_perm:[2,2,2,2] row_mask:0xf bank_mask:0xf
    s_nop 1
    v_mfma_f32_16x16x16_bf16 v[40:43], v[52:53], v[200:201], v[40:43]
    v_mfma_f32_16x16x16_bf16 v[44:47], v[52:53], v[202:203], v[44:47]
    s_waitcnt vmcnt(5)
    buffer_load_dwordx4 v[228:231], v14, s[36:39], s50 offen offset:1024 nt
    v_and_b32_dpp v54, v79, v4 quad_perm:[3,3,3,3] row_mask:0xf bank_mask:0xf
    v_and_b32_dpp v55, v79, v5 quad_perm:[3,3,3,3] row_mask:0xf bank_mask:0xf
    s_nop 1
    v_mfma_f32_16x16x16_bf16 v[40:43], v[54:55], v[204:205], v[40:43]
    v_mfma_f32_16x16x16_bf16 v[44:47], v[54:55], v[206:207], v[44:47]
    v_fma_f32 v80, v80, s53, -v8
    v_exp_f32 v80, v80
    s_nop 0
    v_add_f32 v7, v7, v80
    v_cvt_pk_bf16_f32 v80, v80, v80
    s_waitcnt vmcnt(5)
    buffer_load_dwordx4 v[232:235], v14, s[36:39], s50 offen offset:2048 nt
    v_and_b32_dpp v48, v80, v4 quad_perm:[0,0,0,0] row_mask:0xf bank_mask:0xf
    v_and_b32_dpp v49, v80, v5 quad_perm:[0,0,0,0] row_mask:0xf bank_mask:0xf
    s_nop 1
    v_mfma_f32_16x16x16_bf16 v[40:43], v[48:49], v[208:209], v[40:43]
    v_mfma_f32_16x16x16_bf16 v[44:47], v[48:49], v[210:211], v[44:47]
    s_waitcnt vmcnt(5)
    buffer_load_dwordx4 v[236:239], v14, s[36:39], s50 offen offset:3072 nt
    v_and_b32_dpp v50, v80, v4 quad_perm:[1,1,1,1] row_mask:0xf bank_mask:0xf
    v_and_b32_dpp v51, v80, v5 quad_perm:[1,1,1,1] row_mask:0xf bank_mask:0xf
    s_nop 1
    v_mfma_f32_16x16x16_bf16 v[40:43], v[50:51], v[212:213], v[40:43]
    v_mfma_f32_16x16x16_bf16 v[44:47], v[50:51], v[214:215], v[44:47]
    s_waitcnt vmcnt(5)
    s_add_u32 s50, s50, 65536
    buffer_load_dwordx4 v[240:243], v14, s[36:39], s50 offen offset:0 nt
    v_and_b32_dpp v52, v80, v4 quad_perm:[2,2,2,2] row_mask:0xf bank_mask:0xf
    v_and_b32_dpp v53, v80, v5 quad_perm:[2,2,2,2] row_mask:0xf bank_mask:0xf
    s_nop 1
    v_mfma_f32_16x16x16_bf16 v[40:43], v[52:53], v[216:217], v[40:43]
    v_mfma_f32_16x16x16_bf16 v[44:47], v[52:53], v[218:219], v[44:47]
    s_waitcnt vmcnt(5)
    buffer_load_dwordx4 v[244:247], v14, s[36:39], s50 offen offset:1024 nt
    v_and_b32_dpp v54, v80, v4 quad_perm:[3,3,3,3] row_mask:0xf bank_mask:0xf
    v_and_b32_dpp v55, v80, v5 quad_perm:[3,3,3,3] row_mask:0xf bank_mask:0xf
    s_nop 1
    v_mfma_f32_16x16x16_bf16 v[40:43], v[54:55], v[220:221], v[40:43]
    v_mfma_f32_16x16x16_bf16 v[44:47], v[54:55], v[222:223], v[44:47]
    v_fma_f32 v81, v81, s53, -v8
    v_exp_f32 v81, v81
    s_nop 0
    v_add_f32 v7, v7, v81
    v_cvt_pk_bf16_f32 v81, v81, v81
    s_waitcnt vmcnt(5)
    buffer_load_dwordx4 v[248:251], v14, s[36:39], s50 offen offset:2048 nt
    v_and_b32_dpp v48, v81, v4 quad_perm:[0,0,0,0] row_mask:0xf bank_mask:0xf
    v_and_b32_dpp v49, v81, v5 quad_perm:[0,0,0,0] row_mask:0xf bank_mask:0xf
    s_nop 1
    v_mfma_f32_16x16x16_bf16 v[40:43], v[48:49], v[224:225], v[40:43]
    v_mfma_f32_16x16x16_bf16 v[44:47], v[48:49], v[226:227], v[44:47]
    s_waitcnt vmcnt(5)
    buffer_load_dwordx4 v[252:255], v14, s[36:39], s50 offen offset:3072 nt
    v_and_b32_dpp v50, v81, v4 quad_perm:[1,1,1,1] row_mask:0xf bank_mask:0xf
    v_and_b32_dpp v51, v81, v5 quad_perm:[1,1,1,1] row_mask:0xf bank_mask:0xf
    s_nop 1
    v_mfma_f32_16x16x16_bf16 v[40:43], v[50:51], v[228:229], v[40:43]
    v_mfma_f32_16x16x16_bf16 v[44:47], v[50:51], v[230:231], v[44:47]
    s_cmp_lg_u32 s3, 4
    s_cbranch_scc1 L_cl0
    s_mov_b32 s59, 1
    s_atomic_add s59, s[64:65], 0x1000 glc
L_cl0:
    s_waitcnt vmcnt(5)
    s_add_u32 s50, s50, 65536
    buffer_load_dwordx4 v[96:99], v14, s[36:39], s50 offen offset:0 nt
    v_and_b32_dpp v52, v81, v4 quad_perm:[2,2,2,2] row_mask:0xf bank_mask:0xf
    v_and_b32_dpp v53, v81, v5 quad_perm:[2,2,2,2] row_mask:0xf bank_mask:0xf
    s_nop 1
    v_mfma_f32_16x16x16_bf16 v[40:43], v[52:53], v[232:233], v[40:43]
    v_mfma_f32_16x16x16_bf16 v[44:47], v[52:53], v[234:235], v[44:47]
    s_waitcnt vmcnt(5)
    buffer_load_dwordx4 v[100:103], v14, s[36:39], s50 offen offset:1024 nt
    v_and_b32_dpp v54, v81, v4 quad_perm:[3,3,3,3] row_mask:0xf bank_mask:0xf
    v_and_b32_dpp v55, v81, v5 quad_perm:[3,3,3,3] row_mask:0xf bank_mask:0xf
    s_nop 1
    v_mfma_f32_16x16x16_bf16 v[40:43], v[54:55], v[236:237], v[40:43]
    v_mfma_f32_16x16x16_bf16 v[44:47], v[54:55], v[238:239], v[44:47]
    v_fma_f32 v82, v82, s53, -v8
    v_exp_f32 v82, v82
    s_nop 0
    v_add_f32 v7, v7, v82
    v_cvt_pk_bf16_f32 v82, v82, v82
    s_waitcnt vmcnt(5)
    buffer_load_dwordx4 v[104:107], v14, s[36:39], s50 offen offset:2048 nt
    v_and_b32_dpp v48, v82, v4 quad_perm:[0,0,0,0] row_mask:0xf bank_mask:0xf
    v_and_b32_dpp v49, v82, v5 quad_perm:[0,0,0,0] row_mask:0xf bank_mask:0xf
    s_nop 1
    v_mfma_f32_16x16x16_bf16 v[40:43], v[48:49], v[240:241], v[40:43]
    v_mfma_f32_16x16x16_bf16 v[44:47], v[48:49], v[242:243], v[44:47]
    s_cmp_lg_u32 s3, 4
    s_cbranch_scc1 L_cl1
    s_waitcnt lgkmcnt(0)
    s_min_u32 s59, s59, 1000
    s_add_u32 s59, s59, 1
    v_mov_b32 v89, s59
    s_mov_b64 exec, 1
    ds_write_b32 v88, v89
    v_subrev_u32 v85, 16, v89
    v_max_i32 v85, 0, v85
    ds_write_b32 v10, v85 offset:24
    s_mov_b64 exec, -1
L_cl1:
    ds_read_b32 v89, v88
    s_waitcnt vmcnt(5)
    buffer_load_dwordx4 v[108:111], v14, s[36:39], s50 offen offset:3072 nt
    v_and_b32_dpp v50, v82, v4 quad_perm:[1,1,1,1] row_mask:0xf bank_mask:0xf
    v_and_b32_dpp v51, v82, v5 quad_perm:[1,1,1,1] row_mask:0xf bank_mask:0xf
    s_nop 1
    v_mfma_f32_16x16x16_bf16 v[40:43], v[50:51], v[244:245], v[40:43]
    v_mfma_f32_16x16x16_bf16 v[44:47], v[50:51], v[246:247], v[44:47]
    s_nop 7
L_cl2:
    s_waitcnt lgkmcnt(0)
    v_readfirstlane_b32 s52, v89
    ds_read_b32 v89, v88
    s_cmp_eq_u32 s52, 0
    s_nop 2
    s_cbranch_scc1 L_cl2
    s_cmp_gt_u32 s52, 16
    s_cbranch_scc1 L_nodyn
    s_lshl_b32 s52, s52, 14
    s_add_u32 s52, s52, s62
    v_add_u32 v88, 4, v88
    buffer_load_dwordx4 v[112:115], v2, s[32:35], s52 offen offset:0 nt
    buffer_load_dwordx4 v[116:119], v2, s[32:35], s52 offen offset:128 nt
    s_waitcnt vmcnt(7)
    buffer_load_dwordx4 v[120:123], v2, s[32:35], s52 offen offset:2048 nt
    v_and_b32_dpp v52, v82, v4 quad_perm:[2,2,2,2] row_mask:0xf bank_mask:0xf
    v_and_b32_dpp v53, v82, v5 quad_perm:[2,2,2,2] row_mask:0xf bank_mask:0xf
    s_nop 1
    v_mfma_f32_16x16x16_bf16 v[40:43], v[52:53], v[248:249], v[40:43]
    v_mfma_f32_16x16x16_bf16 v[44:47], v[52:53], v[250:251], v[44:47]
    s_waitcnt vmcnt(7)
    buffer_load_dwordx4 v[124:127], v2, s[32:35], s52 offen offset:2176 nt
    v_and_b32_dpp v54, v82, v4 quad_perm:[3,3,3,3] row_mask:0xf bank_mask:0xf
    v_and_b32_dpp v55, v82, v5 quad_perm:[3,3,3,3] row_mask:0xf bank_mask:0xf
    s_nop 1
    v_mfma_f32_16x16x16_bf16 v[40:43], v[54:55], v[252:253], v[40:43]
    v_mfma_f32_16x16x16_bf16 v[44:47], v[54:55], v[254:255], v[44:47]
    v_fma_f32 v83, v83, s53, -v8
    v_exp_f32 v83, v83
    s_nop 0
    v_add_f32 v7, v7, v83
    v_cvt_pk_bf16_f32 v83, v83, v83
    s_cmp_lg_u32 s3, 4
    s_cbranch_scc1 L_cl3
    s_mov_b32 s59, 1
    s_atomic_add s59, s[64:65], 0x1000 glc
L_cl3:
    s_waitcnt vmcnt(7)
    buffer_load_dwordx4 v[128:131], v14, s[36:39], s52 offen offset:0 nt
    v_and_b32_dpp v48, v83, v4 quad_perm:[0,0,0,0] row_mask:0xf bank_mask:0xf
    v_and_b32_dpp v49, v83, v5 quad_perm:[0,0,0,0] row_mask:0xf bank_mask:0xf
    s_nop 1
    v_mfma_f32_16x16x16_bf16 v[40:43], v[48:49], v[96:97], v[40:43]
    v_mfma_f32_16x16x16_bf16 v[44:47], v[48:49], v[98:99], v[44:47]
    s_waitcnt vmcnt(7)
    buffer_load_dwordx4 v[132:135], v14, s[36:39], s52 offen offset:1024 nt
    v_and_b32_dpp v50, v83, v4 quad_perm:[1,1,1,1] row_mask:0xf bank_mask:0xf
    v_and_b32_dpp v51, v83, v5 quad_perm:[1,1,1,1] row_mask:0xf bank_mask:0xf
    s_nop 1
    v_mfma_f32_16x16x16_bf16 v[40:43], v[50:51], v[100:101], v[40:43]
    v_mfma_f32_16x16x16_bf16 v[44:47], v[50:51], v[102:103], v[44:47]
    s_waitcnt vmcnt(7)
    buffer_load_dwordx4 v[136:139], v14, s[36:39], s52 offen offset:2048 nt
    v_and_b32_dpp v52, v83, v4 quad_perm:[2,2,2,2] row_mask:0xf bank_mask:0xf
    v_and_b32_dpp v53, v83, v5 quad_perm:[2,2,2,2] row_mask:0xf bank_mask:0xf
    s_nop 1
    v_mfma_f32_16x16x16_bf16 v[40:43], v[52:53], v[104:105], v[40:43]
    v_mfma_f32_16x16x16_bf16 v[44:47], v[52:53], v[106:107], v[44:47]
    s_cmp_lg_u32 s3, 4
    s_cbranch_scc1 L_cl4
    s_waitcnt lgkmcnt(0)
    s_min_u32 s59, s59, 1000
    s_add_u32 s59, s59, 1
    v_mov_b32 v89, s59
    s_mov_b64 exec, 1
    ds_write_b32 v88, v89
    v_subrev_u32 v85, 16, v89
    v_max_i32 v85, 0, v85
    ds_write_b32 v10, v85 offset:24
    s_mov_b64 exec, -1
L_cl4:
    ds_read_b32 v89, v88
    s_waitcnt vmcnt(7)
    buffer_load_dwordx4 v[140:143], v14, s[36:39], s52 offen offset:3072 nt
    v_and_b32_dpp v54, v83, v4 quad_perm:[3,3,3,3] row_mask:0xf bank_mask:0xf
    v_and_b32_dpp v55, v83, v5 quad_perm:[3,3,3,3] row_mask:0xf bank_mask:0xf
    s_nop 1
    v_mfma_f32_16x16x16_bf16 v[40:43], v[54:55], v[108:109], v[40:43]
    v_mfma_f32_16x16x16_bf16 v[44:47], v[54:55], v[110:111], v[44:47]
    s_nop 7
L_dyn:
L_cl5:
    s_waitcnt lgkmcnt(0)
    v_readfirstlane_b32 s52, v89
    ds_read_b32 v89, v88
    s_cmp_eq_u32 s52, 0
    s_nop 2
    s_cbranch_scc1 L_cl5
    s_cmp_gt_u32 s52, 16
    s_cbranch_scc1 L_drain0
    s_lshl_b32 s52, s52, 14
    s_add_u32 s52, s52, s62
    v_add_u32 v88, 4, v88
    s_waitcnt vmcnt(7)
    buffer_load_dwordx4 v[144:147], v2, s[32:35], s52 offen offset:0 nt
    s_waitcnt vmcnt(7)
    buffer_load_dwordx4 v[148:151], v2, s[32:35], s52 offen offset:128 nt
    s_waitcnt vmcnt(7)
    buffer_load_dwordx4 v[152:155], v2, s[32:35], s52 offen offset:2048 nt
    s_waitcnt vmcnt(7)
    buffer_load_dwordx4 v[156:159], v2, s[32:35], s52 offen offset:2176 nt
    v_mfma_f32_16x16x32_bf16 v[32:35], v[112:115], v[16:19], 0
    v_mfma_f32_16x16x32_bf16 v[32:35], v[116:119], v[20:23], v[32:35]
    v_mfma_f32_16x16x32_bf16 v[32:35], v[120:123], v[24:27], v[32:35]
    v_mfma_f32_16x16x32_bf16 v[32:35], v[124:127], v[28:31], v[32:35]
    s_cmp_lg_u32 s3, 4
    s_cbranch_scc1 L_cl6
    s_mov_b32 s59, 1
    s_atomic_add s59, s[64:65], 0x1000 glc
L_cl6:
    s_waitcnt vmcnt(7)
    buffer_load_dwordx4 v[160:163], v14, s[36:39], s52 offen offset:0 nt
    s_nop 3
    v_cndmask_b32 v9, v34, v33, s[56:57]
    v_cndmask_b32 v56, v32, v35, s[56:57]
    s_nop 1
    v_add_f32_dpp v56, v9, v56 quad_perm:[1,0,3,2] row_mask:0xf bank_mask:0xf
    v_cvt_pk_bf16_f32 v56, v56, v56
    v_and_b32 v56, s60, v56
    v_mul_f32 v56, s61, v56
    v_cvt_pk_bf16_f32 v56, v56, v56
    v_and_b32 v56, s60, v56
    v_cmp_gt_f32 vcc, v56, v6
    s_nop 4
    s_cbranch_vccz L_nors0
    v_max_f32 v11, v6, v56
    s_nop 1
    v_max_f32_dpp v11, v11, v11 quad_perm:[1,0,3,2] row_mask:0xf bank_mask:0xf
    s_nop 1
    v_max_f32_dpp v11, v11, v11 quad_perm:[2,3,0,1] row_mask:0xf bank_mask:0xf
    v_mov_b32 v9, v11
    s_nop 1
    v_permlane16_swap_b32 v11, v9
    v_max_f32 v11, v11, v9
    v_mov_b32 v9, v11
    s_nop 1
    v_permlane32_swap_b32 v11, v9
    v_max_f32 v11, v11, v9
    v_sub_f32 v9, v6, v11
    v_mul_f32 v9, s53, v9
    v_exp_f32 v9, v9
    v_mov_b32 v6, v11
    v_mul_f32 v8, s53, v11
    v_mul_f32 v7, v7, v9
    v_readlane_b32 s66, v9, 0
    v_readlane_b32 s67, v9, 4
    v_readlane_b32 s68, v9, 8
    v_readlane_b32 s69, v9, 12
    s_mov_b32 exec_lo, 0xffff
    s_mov_b32 exec_hi, 0x0
    v_mov_b32 v9, s66
    s_mov_b32 exec_lo, 0xffff0000
    s_mov_b32 exec_hi, 0x0
    v_mov_b32 v9, s67
    s_mov_b32 exec_lo, 0x0
    s_mov_b32 exec_hi, 0xffff
    v_mov_b32 v9, s68
    s_mov_b32 exec_lo, 0x0
    s_mov_b32 exec_hi, 0xffff0000
    v_mov_b32 v9, s69
    s_mov_b64 exec, -1
    v_mul_f32 v40, v40, v9
    v_mul_f32 v41, v41, v9
    v_mul_f32 v42, v42, v9
    v_mul_f32 v43, v43, v9
    v_mul_f32 v44, v44, v9
    v_mul_f32 v45, v45, v9
    v_mul_f32 v46, v46, v9
    v_mul_f32 v47, v47, v9
    s_nop 1
L_nors0:
    v_fma_f32 v56, v56, s53, -v8
    v_exp_f32 v56, v56
    s_nop 0
    v_add_f32 v7, v7, v56
    v_cvt_pk_bf16_f32 v56, v56, v56
    s_waitcnt vmcnt(7)
    buffer_load_dwordx4 v[164:167], v14, s[36:39], s52 offen offset:1024 nt
    v_and_b32_dpp v48, v56, v4 quad_perm:[0,0,0,0] row_mask:0xf bank_mask:0xf
    v_and_b32_dpp v49, v56, v5 quad_perm:[0,0,0,0] row_mask:0xf bank_mask:0xf
    s_nop 1
    v_mfma_f32_16x16x16_bf16 v[40:43], v[48:49], v[128:129], v[40:43]
    v_mfma_f32_16x16x16_bf16 v[44:47], v[48:49], v[130:131], v[44:47]
    s_waitcnt vmcnt(7)
    buffer_load_dwordx4 v[168:171], v14, s[36:39], s52 offen offset:2048 nt
    v_and_b32_dpp v50, v56, v4 quad_perm:[1,1,1,1] row_mask:0xf bank_mask:0xf
    v_and_b32_dpp v51, v56, v5 quad_perm:[1,1,1,1] row_mask:0xf bank_mask:0xf
    s_nop 1
    v_mfma_f32_16x16x16_bf16 v[40:43], v[50:51], v[132:133], v[40:43]
    v_mfma_f32_16x16x16_bf16 v[44:47], v[50:51], v[134:135], v[44:47]
    s_cmp_lg_u32 s3, 4
    s_cbranch_scc1 L_cl7
    s_waitcnt lgkmcnt(0)
    s_min_u32 s59, s59, 1000
    s_add_u32 s59, s59, 1
    v_mov_b32 v89, s59
    s_mov_b64 exec, 1
    ds_write_b32 v88, v89
    v_subrev_u32 v85, 16, v89
    v_max_i32 v85, 0, v85
    ds_write_b32 v10, v85 offset:24
    s_mov_b64 exec, -1
L_cl7:
    ds_read_b32 v89, v88
    s_waitcnt vmcnt(7)
    buffer_load_dwordx4 v[172:175], v14, s[36:39], s52 offen offset:3072 nt
    v_and_b32_dpp v52, v56, v4 quad_perm:[2,2,2,2] row_mask:0xf bank_mask:0xf
    v_and_b32_dpp v53, v56, v5 quad_perm:[2,2,2,2] row_mask:0xf bank_mask:0xf
    s_nop 1
    v_mfma_f32_16x16x16_bf16 v[40:43], v[52:53], v[136:137], v[40:43]
    v_mfma_f32_16x16x16_bf16 v[44:47], v[52:53], v[138:139], v[44:47]
    v_and_b32_dpp v54, v56, v4 quad_perm:[3,3,3,3] row_mask:0xf bank_mask:0xf
    v_and_b32_dpp v55, v56, v5 quad_perm:[3,3,3,3] row_mask:0xf bank_mask:0xf
    s_nop 1
    v_mfma_f32_16x16x16_bf16 v[40:43], v[54:55], v[140:141], v[40:43]
    v_mfma_f32_16x16x16_bf16 v[44:47], v[54:55], v[142:143], v[44:47]
    s_nop 7
L_cl8:
    s_waitcnt lgkmcnt(0)
    v_readfirstlane_b32 s52, v89
    ds_read_b32 v89, v88
    s_cmp_eq_u32 s52, 0
    s_nop 2
    s_cbranch_scc1 L_cl8
    s_cmp_gt_u32 s52, 16
    s_cbranch_scc1 L_drain1
    s_lshl_b32 s52, s52, 14
    s_add_u32 s52, s52, s62
    v_add_u32 v88, 4, v88
    s_waitcnt vmcnt(7)
    buffer_load_dwordx4 v[112:115], v2, s[32:35], s52 offen offset:0 nt
    s_waitcnt vmcnt(7)
    buffer_load_dwordx4 v[116:119], v2, s[32:35], s52 offen offset:128 nt
    s_waitcnt vmcnt(7)
    buffer_load_dwordx4 v[120:123], v2, s[32:35], s52 offen offset:2048 nt
    s_waitcnt vmcnt(7)
    buffer_load_dwordx4 v[124:127], v2, s[32:35], s52 offen offset:2176 nt
    v_mfma_f32_16x16x32_bf16 v[32:35], v[144:147], v[16:19], 0
    v_mfma_f32_16x16x32_bf16 v[32:35], v[148:151], v[20:23], v[32:35]
    v_mfma_f32_16x16x32_bf16 v[32:35], v[152:155], v[24:27], v[32:35]
    v_mfma_f32_16x16x32_bf16 v[32:35], v[156:159], v[28:31], v[32:35]
    s_cmp_lg_u32 s3, 4
    s_cbranch_scc1 L_cl9
    s_mov_b32 s59, 1
    s_atomic_add s59, s[64:65], 0x1000 glc
L_cl9:
    s_waitcnt vmcnt(7)
    buffer_load_dwordx4 v[128:131], v14, s[36:39], s52 offen offset:0 nt
    s_nop 3
    v_cndmask_b32 v9, v34, v33, s[56:57]
    v_cndmask_b32 v56, v32, v35, s[56:57]
    s_nop 1
    v_add_f32_dpp v56, v9, v56 quad_perm:[1,0,3,2] row_mask:0xf bank_mask:0xf
    v_cvt_pk_bf16_f32 v56, v56, v56
    v_and_b32 v56, s60, v56
    v_mul_f32 v56, s61, v56
    v_cvt_pk_bf16_f32 v56, v56, v56
    v_and_b32 v56, s60, v56
    v_cmp_gt_f32 vcc, v56, v6
    s_nop 4
    s_cbranch_vccz L_nors1
    v_max_f32 v11, v6, v56
    s_nop 1
    v_max_f32_dpp v11, v11, v11 quad_perm:[1,0,3,2] row_mask:0xf bank_mask:0xf
    s_nop 1
    v_max_f32_dpp v11, v11, v11 quad_perm:[2,3,0,1] row_mask:0xf bank_mask:0xf
    v_mov_b32 v9, v11
    s_nop 1
    v_permlane16_swap_b32 v11, v9
    v_max_f32 v11, v11, v9
    v_mov_b32 v9, v11
    s_nop 1
    v_permlane32_swap_b32 v11, v9
    v_max_f32 v11, v11, v9
    v_sub_f32 v9, v6, v11
    v_mul_f32 v9, s53, v9
    v_exp_f32 v9, v9
    v_mov_b32 v6, v11
    v_mul_f32 v8, s53, v11
    v_mul_f32 v7, v7, v9
    v_readlane_b32 s66, v9, 0
    v_readlane_b32 s67, v9, 4
    v_readlane_b32 s68, v9, 8
    v_readlane_b32 s69, v9, 12
    s_mov_b32 exec_lo, 0xffff
    s_mov_b32 exec_hi, 0x0
    v_mov_b32 v9, s66
    s_mov_b32 exec_lo, 0xffff0000
    s_mov_b32 exec_hi, 0x0
    v_mov_b32 v9, s67
    s_mov_b32 exec_lo, 0x0
    s_mov_b32 exec_hi, 0xffff
    v_mov_b32 v9, s68
    s_mov_b32 exec_lo, 0x0
    s_mov_b32 exec_hi, 0xffff0000
    v_mov_b32 v9, s69
    s_mov_b64 exec, -1
    v_mul_f32 v40, v40, v9
    v_mul_f32 v41, v41, v9
    v_mul_f32 v42, v42, v9
    v_mul_f32 v43, v43, v9
    v_mul_f32 v44, v44, v9
    v_mul_f32 v45, v45, v9
    v_mul_f32 v46, v46, v9
    v_mul_f32 v47, v47, v9
    s_nop 1
L_nors1:
    v_fma_f32 v56, v56, s53, -v8
    v_exp_f32 v56, v56
    s_nop 0
    v_add_f32 v7, v7, v56
    v_cvt_pk_bf16_f32 v56, v56, v56
    s_waitcnt vmcnt(7)
    buffer_load_dwordx4 v[132:135], v14, s[36:39], s52 offen offset:1024 nt
    v_and_b32_dpp v48, v56, v4 quad_perm:[0,0,0,0] row_mask:0xf bank_mask:0xf
    v_and_b32_dpp v49, v56, v5 quad_perm:[0,0,0,0] row_mask:0xf bank_mask:0xf
    s_nop 1
    v_mfma_f32_16x16x16_bf16 v[40:43], v[48:49], v[160:161], v[40:43]
    v_mfma_f32_16x16x16_bf16 v[44:47], v[48:49], v[162:163], v[44:47]
    s_waitcnt vmcnt(7)
    buffer_load_dwordx4 v[136:139], v14, s[36:39], s52 offen offset:2048 nt
    v_and_b32_dpp v50, v56, v4 quad_perm:[1,1,1,1] row_mask:0xf bank_mask:0xf
    v_and_b32_dpp v51, v56, v5 quad_perm:[1,1,1,1] row_mask:0xf bank_mask:0xf
    s_nop 1
    v_mfma_f32_16x16x16_bf16 v[40:43], v[50:51], v[164:165], v[40:43]
    v_mfma_f32_16x16x16_bf16 v[44:47], v[50:51], v[166:167], v[44:47]
    s_cmp_lg_u32 s3, 4
    s_cbranch_scc1 L_cl10
    s_waitcnt lgkmcnt(0)
    s_min_u32 s59, s59, 1000
    s_add_u32 s59, s59, 1
    v_mov_b32 v89, s59
    s_mov_b64 exec, 1
    ds_write_b32 v88, v89
    v_subrev_u32 v85, 16, v89
    v_max_i32 v85, 0, v85
    ds_write_b32 v10, v85 offset:24
    s_mov_b64 exec, -1
L_cl10:
    ds_read_b32 v89, v88
    s_waitcnt vmcnt(7)
    buffer_load_dwordx4 v[140:143], v14, s[36:39], s52 offen offset:3072 nt
    v_and_b32_dpp v52, v56, v4 quad_perm:[2,2,2,2] row_mask:0xf bank_mask:0xf
    v_and_b32_dpp v53, v56, v5 quad_perm:[2,2,2,2] row_mask:0xf bank_mask:0xf
    s_nop 1
    v_mfma_f32_16x16x16_bf16 v[40:43], v[52:53], v[168:169], v[40:43]
    v_mfma_f32_16x16x16_bf16 v[44:47], v[52:53], v[170:171], v[44:47]
    v_and_b32_dpp v54, v56, v4 quad_perm:[3,3,3,3] row_mask:0xf bank_mask:0xf
    v_and_b32_dpp v55, v56, v5 quad_perm:[3,3,3,3] row_mask:0xf bank_mask:0xf
    s_nop 1
    v_mfma_f32_16x16x16_bf16 v[40:43], v[54:55], v[172:173], v[40:43]
    v_mfma_f32_16x16x16_bf16 v[44:47], v[54:55], v[174:175], v[44:47]
    s_nop 7
    s_branch L_dyn
L_drain0:
    s_waitcnt vmcnt(4)
    v_mfma_f32_16x16x32_bf16 v[32:35], v[112:115], v[16:19], 0
    v_mfma_f32_16x16x32_bf16 v[32:35], v[116:119], v[20:23], v[32:35]
    v_mfma_f32_16x16x32_bf16 v[32:35], v[120:123], v[24:27], v[32:35]
    v_mfma_f32_16x16x32_bf16 v[32:35], v[124:127], v[28:31], v[32:35]
    s_nop 7
    v_cndmask_b32 v9, v34, v33, s[56:57]
    v_cndmask_b32 v56, v32, v35, s[56:57]
    s_nop 1
    v_add_f32_dpp v56, v9, v56 quad_perm:[1,0,3,2] row_mask:0xf bank_mask:0xf
    v_cvt_pk_bf16_f32 v56, v56, v56
    v_and_b32 v56, s60, v56
    v_mul_f32 v56, s61, v56
    v_cvt_pk_bf16_f32 v56, v56, v56
    v_and_b32 v56, s60, v56
    v_cmp_gt_f32 vcc, v56, v6
    s_nop 4
    s_cbranch_vccz L_nors2
    v_max_f32 v11, v6, v56
    s_nop 1
    v_max_f32_dpp v11, v11, v11 quad_perm:[1,0,3,2] row_mask:0xf bank_mask:0xf
    s_nop 1
    v_max_f32_dpp v11, v11, v11 quad_perm:[2,3,0,1] row_mask:0xf bank_mask:0xf
    v_mov_b32 v9, v11
    s_nop 1
    v_permlane16_swap_b32 v11, v9
    v_max_f32 v11, v11, v9
    v_mov_b32 v9, v11
    s_nop 1
    v_permlane32_swap_b32 v11, v9
    v_max_f32 v11, v11, v9
    v_sub_f32 v9, v6, v11
    v_mul_f32 v9, s53, v9
    v_exp_f32 v9, v9
    v_mov_b32 v6, v11
    v_mul_f32 v8, s53, v11
    v_mul_f32 v7, v7, v9
    v_readlane_b32 s66, v9, 0
    v_readlane_b32 s67, v9, 4
    v_readlane_b32 s68, v9, 8
    v_readlane_b32 s69, v9, 12
    s_mov_b32 exec_lo, 0xffff
    s_mov_b32 exec_hi, 0x0
    v_mov_b32 v9, s66
    s_mov_b32 exec_lo, 0xffff0000
    s_mov_b32 exec_hi, 0x0
    v_mov_b32 v9, s67
    s_mov_b32 exec_lo, 0x0
    s_mov_b32 exec_hi, 0xffff
    v_mov_b32 v9, s68
    s_mov_b32 exec_lo, 0x0
    s_mov_b32 exec_hi, 0xffff0000
    v_mov_b32 v9, s69
    s_mov_b64 exec, -1
    v_mul_f32 v40, v40, v9
    v_mul_f32 v41, v41, v9
    v_mul_f32 v42, v42, v9
    v_mul_f32 v43, v43, v9
    v_mul_f32 v44, v44, v9
    v_mul_f32 v45, v45, v9
    v_mul_f32 v46, v46, v9
    v_mul_f32 v47, v47, v9
    s_nop 1
L_nors2:
    v_fma_f32 v56, v56, s53, -v8
    v_exp_f32 v56, v56
    s_nop 0
    v_add_f32 v7, v7, v56
    v_cvt_pk_bf16_f32 v56, v56, v56
    s_nop 0
    v_add_f32_dpp v7, v7, v7 quad_perm:[1,0,3,2] row_mask:0xf bank_mask:0xf
    s_nop 1
    v_add_f32_dpp v7, v7, v7 quad_perm:[2,3,0,1] row_mask:0xf bank_mask:0xf
    v_mov_b32 v9, v7
    s_nop 1
    v_permlane16_swap_b32 v7, v9
    v_add_f32 v7, v7, v9
    v_mov_b32 v9, v7
    s_nop 1
    v_permlane32_swap_b32 v7, v9
    v_add_f32 v7, v7, v9
    s_mov_b64 exec, 0x1111
    ds_write_b64 v87, v[6:7]
    v_mov_b32 v11, 1
    s_mov_b64 exec, 1
    ds_add_u32 v10, v11 offset:16
    s_mov_b64 exec, -1
    v_and_b32_dpp v48, v56, v4 quad_perm:[0,0,0,0] row_mask:0xf bank_mask:0xf
    v_and_b32_dpp v49, v56, v5 quad_perm:[0,0,0,0] row_mask:0xf bank_mask:0xf
    v_and_b32_dpp v50, v56, v4 quad_perm:[1,1,1,1] row_mask:0xf bank_mask:0xf
    v_and_b32_dpp v51, v56, v5 quad_perm:[1,1,1,1] row_mask:0xf bank_mask:0xf
    v_and_b32_dpp v52, v56, v4 quad_perm:[2,2,2,2] row_mask:0xf bank_mask:0xf
    v_and_b32_dpp v53, v56, v5 quad_perm:[2,2,2,2] row_mask:0xf bank_mask:0xf
    v_and_b32_dpp v54, v56, v4 quad_perm:[3,3,3,3] row_mask:0xf bank_mask:0xf
    v_and_b32_dpp v55, v56, v5 quad_perm:[3,3,3,3] row_mask:0xf bank_mask:0xf
    s_waitcnt vmcnt(3)
    v_mfma_f32_16x16x16_bf16 v[40:43], v[48:49], v[128:129], v[40:43]
    v_mfma_f32_16x16x16_bf16 v[44:47], v[48:49], v[130:131], v[44:47]
    s_waitcnt vmcnt(2)
    v_mfma_f32_16x16x16_bf16 v[40:43], v[50:51], v[132:133], v[40:43]
    v_mfma_f32_16x16x16_bf16 v[44:47], v[50:51], v[134:135], v[44:47]
    s_waitcnt vmcnt(1)
    v_mfma_f32_16x16x16_bf16 v[40:43], v[52:53], v[136:137], v[40:43]
    v_mfma_f32_16x16x16_bf16 v[44:47], v[52:53], v[138:139], v[44:47]
    s_waitcnt vmcnt(0)
    v_mfma_f32_16x16x16_bf16 v[40:43], v[54:55], v[140:141], v[40:43]
    v_mfma_f32_16x16x16_bf16 v[44:47], v[54:55], v[142:143], v[44:47]
    s_nop 7
    s_branch L_sdone
L_drain1:
    s_waitcnt vmcnt(4)
    v_mfma_f32_16x16x32_bf16 v[32:35], v[144:147], v[16:19], 0
    v_mfma_f32_16x16x32_bf16 v[32:35], v[148:151], v[20:23], v[32:35]
    v_mfma_f32_16x16x32_bf16 v[32:35], v[152:155], v[24:27], v[32:35]
    v_mfma_f32_16x16x32_bf16 v[32:35], v[156:159], v[28:31], v[32:35]
    s_nop 7
    v_cndmask_b32 v9, v34, v33, s[56:57]
    v_cndmask_b32 v56, v32, v35, s[56:57]
    s_nop 1
    v_add_f32_dpp v56, v9, v56 quad_perm:[1,0,3,2] row_mask:0xf bank_mask:0xf
    v_cvt_pk_bf16_f32 v56, v56, v56
    v_and_b32 v56, s60, v56
    v_mul_f32 v56, s61, v56
    v_cvt_pk_bf16_f32 v56, v56, v56
    v_and_b32 v56, s60, v56
    v_cmp_gt_f32 vcc, v56, v6
    s_nop 4
    s_cbranch_vccz L_nors3
    v_max_f32 v11, v6, v56
    s_nop 1
    v_max_f32_dpp v11, v11, v11 quad_perm:[1,0,3,2] row_mask:0xf bank_mask:0xf
    s_nop 1
    v_max_f32_dpp v11, v11, v11 quad_perm:[2,3,0,1] row_mask:0xf bank_mask:0xf
    v_mov_b32 v9, v11
    s_nop 1
    v_permlane16_swap_b32 v11, v9
    v_max_f32 v11, v11, v9
    v_mov_b32 v9, v11
    s_nop 1
    v_permlane32_swap_b32 v11, v9
    v_max_f32 v11, v11, v9
    v_sub_f32 v9, v6, v11
    v_mul_f32 v9, s53, v9
    v_exp_f32 v9, v9
    v_mov_b32 v6, v11
    v_mul_f32 v8, s53, v11
    v_mul_f32 v7, v7, v9
    v_readlane_b32 s66, v9, 0
    v_readlane_b32 s67, v9, 4
    v_readlane_b32 s68, v9, 8
    v_readlane_b32 s69, v9, 12
    s_mov_b32 exec_lo, 0xffff
    s_mov_b32 exec_hi, 0x0
    v_mov_b32 v9, s66
    s_mov_b32 exec_lo, 0xffff0000
    s_mov_b32 exec_hi, 0x0
    v_mov_b32 v9, s67
    s_mov_b32 exec_lo, 0x0
    s_mov_b32 exec_hi, 0xffff
    v_mov_b32 v9, s68
    s_mov_b32 exec_lo, 0x0
    s_mov_b32 exec_hi, 0xffff0000
    v_mov_b32 v9, s69
    s_mov_b64 exec, -1
    v_mul_f32 v40, v40, v9
    v_mul_f32 v41, v41, v9
    v_mul_f32 v42, v42, v9
    v_mul_f32 v43, v43, v9
    v_mul_f32 v44, v44, v9
    v_mul_f32 v45, v45, v9
    v_mul_f32 v46, v46, v9
    v_mul_f32 v47, v47, v9
    s_nop 1
L_nors3:
    v_fma_f32 v56, v56, s53, -v8
    v_exp_f32 v56, v56
    s_nop 0
    v_add_f32 v7, v7, v56
    v_cvt_pk_bf16_f32 v56, v56, v56
    s_nop 0
    v_add_f32_dpp v7, v7, v7 quad_perm:[1,0,3,2] row_mask:0xf bank_mask:0xf
    s_nop 1
    v_add_f32_dpp v7, v7, v7 quad_perm:[2,3,0,1] row_mask:0xf bank_mask:0xf
    v_mov_b32 v9, v7
    s_nop 1
    v_permlane16_swap_b32 v7, v9
    v_add_f32 v7, v7, v9
    v_mov_b32 v9, v7
    s_nop 1
    v_permlane32_swap_b32 v7, v9
    v_add_f32 v7, v7, v9
    s_mov_b64 exec, 0x1111
    ds_write_b64 v87, v[6:7]
    v_mov_b32 v11, 1
    s_mov_b64 exec, 1
    ds_add_u32 v10, v11 offset:16
    s_mov_b64 exec, -1
    v_and_b32_dpp v48, v56, v4 quad_perm:[0,0,0,0] row_mask:0xf bank_mask:0xf
    v_and_b32_dpp v49, v56, v5 quad_perm:[0,0,0,0] row_mask:0xf bank_mask:0xf
    v_and_b32_dpp v50, v56, v4 quad_perm:[1,1,1,1] row_mask:0xf bank_mask:0xf
    v_and_b32_dpp v51, v56, v5 quad_perm:[1,1,1,1] row_mask:0xf bank_mask:0xf
    v_and_b32_dpp v52, v56, v4 quad_perm:[2,2,2,2] row_mask:0xf bank_mask:0xf
    v_and_b32_dpp v53, v56, v5 quad_perm:[2,2,2,2] row_mask:0xf bank_mask:0xf
    v_and_b32_dpp v54, v56, v4 quad_perm:[3,3,3,3] row_mask:0xf bank_mask:0xf
    v_and_b32_dpp v55, v56, v5 quad_perm:[3,3,3,3] row_mask:0xf bank_mask:0xf
    s_waitcnt vmcnt(3)
    v_mfma_f32_16x16x16_bf16 v[40:43], v[48:49], v[160:161], v[40:43]
    v_mfma_f32_16x16x16_bf16 v[44:47], v[48:49], v[162:163], v[44:47]
    s_waitcnt vmcnt(2)
    v_mfma_f32_16x16x16_bf16 v[40:43], v[50:51], v[164:165], v[40:43]
    v_mfma_f32_16x16x16_bf16 v[44:47], v[50:51], v[166:167], v[44:47]
    s_waitcnt vmcnt(1)
    v_mfma_f32_16x16x16_bf16 v[40:43], v[52:53], v[168:169], v[40:43]
    v_mfma_f32_16x16x16_bf16 v[44:47], v[52:53], v[170:171], v[44:47]
    s_waitcnt vmcnt(0)
    v_mfma_f32_16x16x16_bf16 v[40:43], v[54:55], v[172:173], v[40:43]
    v_mfma_f32_16x16x16_bf16 v[44:47], v[54:55], v[174:175], v[44:47]
    s_nop 7
    s_branch L_sdone
L_nodyn:
    s_waitcnt vmcnt(5)
    v_and_b32_dpp v52, v82, v4 quad_perm:[2,2,2,2] row_mask:0xf bank_mask:0xf
    v_and_b32_dpp v53, v82, v5 quad_perm:[2,2,2,2] row_mask:0xf bank_mask:0xf
    s_nop 1
    v_mfma_f32_16x16x16_bf16 v[40:43], v[52:53], v[248:249], v[40:43]
    v_mfma_f32_16x16x16_bf16 v[44:47], v[52:53], v[250:251], v[44:47]
    s_waitcnt vmcnt(4)
    v_and_b32_dpp v54, v82, v4 quad_perm:[3,3,3,3] row_mask:0xf bank_mask:0xf
    v_and_b32_dpp v55, v82, v5 quad_perm:[3,3,3,3] row_mask:0xf bank_mask:0xf
    s_nop 1
    v_mfma_f32_16x16x16_bf16 v[40:43], v[54:55], v[252:253], v[40:43]
    v_mfma_f32_16x16x16_bf16 v[44:47], v[54:55], v[254:255], v[44:47]
    v_fma_f32 v83, v83, s53, -v8
    v_exp_f32 v83, v83
    s_nop 0
    v_add_f32 v7, v7, v83
    v_cvt_pk_bf16_f32 v83, v83, v83
    s_waitcnt vmcnt(3)
    s_nop 0
    v_and_b32_dpp v48, v83, v4 quad_perm:[0,0,0,0] row_mask:0xf bank_mask:0xf
    v_and_b32_dpp v49, v83, v5 quad_perm:[0,0,0,0] row_mask:0xf bank_mask:0xf
    s_nop 1
    v_mfma_f32_16x16x16_bf16 v[40:43], v[48:49], v[96:97], v[40:43]
    v_mfma_f32_16x16x16_bf16 v[44:47], v[48:49], v[98:99], v[44:47]
    s_waitcnt vmcnt(2)
    v_and_b32_dpp v50, v83, v4 quad_perm:[1,1,1,1] row_mask:0xf bank_mask:0xf
    v_and_b32_dpp v51, v83, v5 quad_perm:[1,1,1,1] row_mask:0xf bank_mask:0xf
    s_nop 1
    v_mfma_f32_16x16x16_bf16 v[40:43], v[50:51], v[100:101], v[40:43]
    v_mfma_f32_16x16x16_bf16 v[44:47], v[50:51], v[102:103], v[44:47]
    s_waitcnt vmcnt(1)
    v_and_b32_dpp v52, v83, v4 quad_perm:[2,2,2,2] row_mask:0xf bank_mask:0xf
    v_and_b32_dpp v53, v83, v5 quad_perm:[2,2,2,2] row_mask:0xf bank_mask:0xf
    s_nop 1
    v_mfma_f32_16x16x16_bf16 v[40:43], v[52:53], v[104:105], v[40:43]
    v_mfma_f32_16x16x16_bf16 v[44:47], v[52:53], v[106:107], v[44:47]
    s_waitcnt vmcnt(0)
    v_and_b32_dpp v54, v83, v4 quad_perm:[3,3,3,3] row_mask:0xf bank_mask:0xf
    v_and_b32_dpp v55, v83, v5 quad_perm:[3,3,3,3] row_mask:0xf bank_mask:0xf
    s_nop 1
    v_mfma_f32_16x16x16_bf16 v[40:43], v[54:55], v[108:109], v[40:43]
    v_mfma_f32_16x16x16_bf16 v[44:47], v[54:55], v[110:111], v[44:47]
    v_add_f32_dpp v7, v7, v7 quad_perm:[1,0,3,2] row_mask:0xf bank_mask:0xf
    s_nop 1
    v_add_f32_dpp v7, v7, v7 quad_perm:[2,3,0,1] row_mask:0xf bank_mask:0xf
    v_mov_b32 v9, v7
    s_nop 1
    v_permlane16_swap_b32 v7, v9
    v_add_f32 v7, v7, v9
    v_mov_b32 v9, v7
    s_nop 1
    v_permlane32_swap_b32 v7, v9
    v_add_f32 v7, v7, v9
    s_mov_b64 exec, 0x1111
    ds_write_b64 v87, v[6:7]
    v_mov_b32 v11, 1
    s_mov_b64 exec, 1
    ds_add_u32 v10, v11 offset:16
    s_mov_b64 exec, -1
L_sdone:
    ds_write_b128 v3, v[40:43]
    ds_write_b128 v3, v[44:47] offset:16
    s_waitcnt lgkmcnt(0)
    s_barrier
    s_and_b32 s79, s49, 0xffff
L_a_first:
    ds_read_b32 v16, v10 offset:20
    s_waitcnt lgkmcnt(0)
    v_readfirstlane_b32 s50, v16
    s_nop 0
    s_cmp_lt_u32 s50, 1
    s_nop 2
    s_cbranch_scc1 L_a_first
    s_mov_b32 s50, 0x07060302
    buffer_load_dwordx4 v[100:103], v84, s[40:43], s78 offen offset:0 sc1
    buffer_load_dwordx4 v[104:107], v84, s[40:43], s78 offen offset:512 sc1
    buffer_load_dwordx4 v[108:111], v84, s[40:43], s78 offen offset:1024 sc1
    buffer_load_dwordx4 v[112:115], v84, s[40:43], s78 offen offset:1536 sc1
    s_branch L_a_chk
L_a_poll:
    s_cmp_lg_u32 s66, 0
    s_cselect_b32 s66, -1, 0
    s_cmp_lg_u32 s67, 0
    s_cselect_b32 s67, -1, 0
    s_cmp_lg_u32 s68, 0
    s_cselect_b32 s68, -1, 0
    s_cmp_lg_u32 s69, 0
    s_cselect_b32 s69, -1, 0
    s_cmp_lg_u32 s70, 0
    s_cselect_b32 s70, -1, 0
    s_cmp_lg_u32 s71, 0
    s_cselect_b32 s71, -1, 0
    s_cmp_lg_u32 s72, 0
    s_cselect_b32 s72, -1, 0
    s_cmp_lg_u32 s73, 0
    s_cselect_b32 s73, -1, 0
    s_mov_b64 exec, s[66:67]
    s_cbranch_execz L_a_skip0
    buffer_load_dwordx4 v[100:103], v84, s[40:43], s78 offen offset:0 sc1
L_a_skip0:
    s_mov_b64 exec, s[68:69]
    s_cbranch_execz L_a_skip1
    buffer_load_dwordx4 v[104:107], v84, s[40:43], s78 offen offset:512 sc1
L_a_skip1:
    s_mov_b64 exec, s[70:71]
    s_cbranch_execz L_a_skip2
    buffer_load_dwordx4 v[108:111], v84, s[40:43], s78 offen offset:1024 sc1
L_a_skip2:
    s_mov_b64 exec, s[72:73]
    s_cbranch_execz L_a_skip3
    buffer_load_dwordx4 v[112:115], v84, s[40:43], s78 offen offset:1536 sc1
L_a_skip3:
    s_mov_b64 exec, -1
    s_addk_i32 s58, -1
    s_cmp_lt_i32 s58, 0
    s_cbranch_scc1 L_a_ok
L_a_chk:
    s_waitcnt vmcnt(0)
    v_cmp_ne_u16 s[66:67], s79, v101
    v_cmp_ne_u16 s[74:75], s79, v103
    v_cmp_ne_u16 s[68:69], s79, v105
    v_cmp_ne_u16 s[76:77], s79, v107
    s_or_b64 s[66:67], s[66:67], s[74:75]
    v_cmp_ne_u16 s[70:71], s79, v109
    v_cmp_ne_u16 s[74:75], s79, v111
    s_or_b64 s[68:69], s[68:69], s[76:77]
    v_cmp_ne_u16 s[72:73], s79, v113
    v_cmp_ne_u16 s[76:77], s79, v115
    s_or_b64 s[70:71], s[70:71], s[74:75]
    s_or_b64 s[56:57], s[66:67], s[68:69]
    s_or_b64 s[72:73], s[72:73], s[76:77]
    s_or_b64 vcc, s[70:71], s[72:73]
    s_or_b64 vcc, vcc, s[56:57]
    s_cbranch_scc1 L_a_poll
L_a_ok:
    s_waitcnt vmcnt(0)
    v_perm_b32 v20, v101, v103, s50
    v_perm_b32 v21, v105, v107, s50
    v_perm_b32 v22, v109, v111, s50
    v_perm_b32 v23, v113, v115, s50
    v_max3_f32 v16, v20, v21, v22
    v_max_f32 v16, v16, v23
    v_sub_f32 v20, v20, v16
    v_sub_f32 v21, v21, v16
    v_sub_f32 v22, v22, v16
    v_sub_f32 v23, v23, v16
    v_exp_f32 v20, v20
    v_exp_f32 v21, v21
    v_exp_f32 v22, v22
    v_exp_f32 v23, v23
    v_and_b32 v121, s60, v100
    v_lshlrev_b32 v120, 16, v100
    v_and_b32 v123, s60, v102
    v_lshlrev_b32 v122, 16, v102
    v_add_f32 v16, v20, v21
    v_add_f32 v17, v22, v23
    v_add_f32 v16, v16, v17
    v_rcp_f32 v16, v16
    v_pk_mul_f32 v[24:25], v[20:21], v[120:121] op_sel:[0,0] op_sel_hi:[0,1]
    v_pk_mul_f32 v[26:27], v[20:21], v[122:123] op_sel:[0,0] op_sel_hi:[0,1]
    v_and_b32 v125, s60, v104
    v_lshlrev_b32 v124, 16, v104
    v_and_b32 v127, s60, v106
    v_lshlrev_b32 v126, 16, v106
    v_pk_fma_f32 v[24:25], v[20:21], v[124:125], v[24:25] op_sel:[1,0,0] op_sel_hi:[1,1,1]
    v_pk_fma_f32 v[26:27], v[20:21], v[126:127], v[26:27] op_sel:[1,0,0] op_sel_hi:[1,1,1]
    v_and_b32 v129, s60, v108
    v_lshlrev_b32 v128, 16, v108
    v_and_b32 v131, s60, v110
    v_lshlrev_b32 v130, 16, v110
    v_pk_fma_f32 v[24:25], v[22:23], v[128:129], v[24:25] op_sel:[0,0,0] op_sel_hi:[0,1,1]
    v_pk_fma_f32 v[26:27], v[22:23], v[130:131], v[26:27] op_sel:[0,0,0] op_sel_hi:[0,1,1]
    v_and_b32 v133, s60, v112
    v_lshlrev_b32 v132, 16, v112
    v_and_b32 v135, s60, v114
    v_lshlrev_b32 v134, 16, v114
    v_pk_fma_f32 v[24:25], v[22:23], v[132:133], v[24:25] op_sel:[1,0,0] op_sel_hi:[1,1,1]
    v_pk_fma_f32 v[26:27], v[22:23], v[134:135], v[26:27] op_sel:[1,0,0] op_sel_hi:[1,1,1]
    v_pk_mul_f32 v[24:25], v[16:17], v[24:25] op_sel:[0,0] op_sel_hi:[0,1]
    v_pk_mul_f32 v[26:27], v[16:17], v[26:27] op_sel:[0,0] op_sel_hi:[0,1]
    v_cvt_pk_bf16_f32 v24, v24, v25
    v_cvt_pk_bf16_f32 v25, v26, v27
    ds_write_b64 v86, v[24:25]
    s_waitcnt lgkmcnt(0)
    s_barrier
    s_cmp_lg_u32 s3, 4
    s_cbranch_scc1 L_fin
    s_cmp_ge_u32 s5, 16
    s_cbranch_scc1 L_fin
    s_mov_b32 s44, s8
    s_and_b32 s45, s9, 0xffff
    s_mov_b32 s46, 0x2000
    s_mov_b32 s47, 0x20000
    s_mov_b32 s32, s26
    s_and_b32 s33, s27, 0xffff
    s_mov_b32 s34, 0x2000
    s_mov_b32 s35, 0x20000
    v_bfe_u32 v9, v1, 2, 1
    v_lshlrev_b32 v9, 10, v9
    v_and_b32 v11, 3, v1
    v_lshl_add_u32 v9, v11, 3, v9
    v_lshrrev_b32 v11, 5, v1
    v_lshl_add_u32 v9, v11, 2, v9
    s_and_b32 s52, s5, 3
    s_lshl_b32 s52, s52, 11
    s_lshl_b32 s50, s4, 7
    s_add_u32 s52, s52, s50
    s_lshr_b32 s50, s5, 2
    s_lshl_b32 s50, s50, 5
    s_add_u32 s52, s52, s50
    buffer_load_dword v20, v9, s[44:47], s52 offen
    s_lshl_b32 s51, s4, 4
    s_add_u32 s51, s51, s5
    s_lshl_b32 s51, s51, 12
    s_add_u32 s51, s51, 2097152
L_b_first:
    ds_read_b32 v16, v10 offset:12
    s_waitcnt lgkmcnt(0)
    v_readfirstlane_b32 s50, v16
    s_nop 0
    s_cmp_lt_u32 s50, 5
    s_nop 2
    s_cbranch_scc1 L_b_first
    s_mov_b32 s50, 0x0c0c0400
    s_mov_b32 s61, 0xffffff00
    buffer_load_dwordx4 v[100:103], v14, s[40:43], s51 offen offset:0 sc1
    buffer_load_dwordx4 v[104:107], v14, s[40:43], s51 offen offset:1024 sc1
    buffer_load_dwordx4 v[108:111], v14, s[40:43], s51 offen offset:2048 sc1
    buffer_load_dwordx4 v[112:115], v14, s[40:43], s51 offen offset:3072 sc1
    s_branch L_b_chk
L_b_poll:
    s_wqm_b64 s[66:67], s[66:67]
    s_wqm_b64 s[68:69], s[68:69]
    s_wqm_b64 s[70:71], s[70:71]
    s_wqm_b64 s[72:73], s[72:73]
    s_mov_b64 exec, s[66:67]
    s_cbranch_execz L_b_skip0
    buffer_load_dwordx4 v[100:103], v14, s[40:43], s51 offen offset:0 sc1
L_b_skip0:
    s_mov_b64 exec, s[68:69]
    s_cbranch_execz L_b_skip1
    buffer_load_dwordx4 v[104:107], v14, s[40:43], s51 offen offset:1024 sc1
L_b_skip1:
    s_mov_b64 exec, s[70:71]
    s_cbranch_execz L_b_skip2
    buffer_load_dwordx4 v[108:111], v14, s[40:43], s51 offen offset:2048 sc1
L_b_skip2:
    s_mov_b64 exec, s[72:73]
    s_cbranch_execz L_b_skip3
    buffer_load_dwordx4 v[112:115], v14, s[40:43], s51 offen offset:3072 sc1
L_b_skip3:
    s_mov_b64 exec, -1
    s_addk_i32 s58, -1
    s_cmp_lt_i32 s58, 0
    s_cbranch_scc1 L_b_ok
L_b_chk:
    s_waitcnt vmcnt(0)
    v_perm_b32 v120, v101, v100, s50
    v_perm_b32 v121, v103, v102, s50
    v_perm_b32 v122, v105, v104, s50
    v_perm_b32 v123, v107, v106, s50
    v_perm_b32 v124, v109, v108, s50
    v_perm_b32 v125, v111, v110, s50
    v_perm_b32 v126, v113, v112, s50
    v_perm_b32 v127, v115, v114, s50
    v_cmp_ne_u32 s[66:67], s79, v120
    v_cmp_ne_u32 s[74:75], s79, v121
    v_cmp_ne_u32 s[68:69], s79, v122
    v_cmp_ne_u32 s[76:77], s79, v123
    s_or_b64 s[66:67], s[66:67], s[74:75]
    v_cmp_ne_u32 s[70:71], s79, v124
    v_cmp_ne_u32 s[74:75], s79, v125
    s_or_b64 s[68:69], s[68:69], s[76:77]
    v_cmp_ne_u32 s[72:73], s79, v126
    v_cmp_ne_u32 s[76:77], s79, v127
    s_or_b64 s[70:71], s[70:71], s[74:75]
    s_or_b64 s[56:57], s[66:67], s[68:69]
    s_or_b64 s[72:73], s[72:73], s[76:77]
    s_or_b64 vcc, s[70:71], s[72:73]
    s_or_b64 vcc, vcc, s[56:57]
    s_cbranch_scc1 L_b_poll
L_b_ok:
    s_waitcnt vmcnt(0)
    v_and_b32 v100, s61, v100
    v_and_b32 v101, s61, v101
    v_and_b32 v102, s61, v102
    v_and_b32 v103, s61, v103
    v_and_b32 v104, s61, v104
    v_and_b32 v105, s61, v105
    v_and_b32 v106, s61, v106
    v_and_b32 v107, s61, v107
    v_and_b32 v108, s61, v108
    v_and_b32 v109, s61, v109
    v_and_b32 v110, s61, v110
    v_and_b32 v111, s61, v111
    v_and_b32 v112, s61, v112
    v_and_b32 v113, s61, v113
    v_and_b32 v114, s61, v114
    v_and_b32 v115, s61, v115
    v_pk_add_f32 v[100:101], v[100:101], v[104:105]
    v_pk_add_f32 v[108:109], v[108:109], v[112:113]
    v_pk_add_f32 v[102:103], v[102:103], v[106:107]
    v_pk_add_f32 v[110:111], v[110:111], v[114:115]
    v_pk_add_f32 v[100:101], v[100:101], v[108:109]
    v_pk_add_f32 v[102:103], v[102:103], v[110:111]
    v_lshlrev_b32 v22, 16, v20
    v_and_b32 v23, s60, v20
    v_permlane32_swap_b32 v100, v102
    v_permlane32_swap_b32 v101, v103
    v_add_f32 v16, v100, v102
    v_add_f32 v17, v101, v103
    v_mov_b32 v18, v16
    v_mov_b32 v19, v17
    s_nop 0
    v_permlane16_swap_b32 v16, v18
    v_permlane16_swap_b32 v17, v19
    v_add_f32 v16, v16, v18
    v_add_f32 v17, v17, v19
    s_nop 0
    v_add_f32_dpp v16, v16, v16 row_ror:8 row_mask:0xf bank_mask:0xf
    v_add_f32_dpp v17, v17, v17 row_ror:8 row_mask:0xf bank_mask:0xf
    v_add_f32 v16, v16, v22
    v_add_f32 v17, v17, v23
    v_cvt_pk_bf16_f32 v16, v16, v17
    s_mov_b32 exec_lo, 0xff
    s_mov_b32 exec_hi, 0xff
    buffer_store_dword v16, v9, s[32:35], s52 offen sc1
    s_cmp_lg_u32 s2, 0
    s_cbranch_scc1 L_fin
    s_mov_b64 exec, 3
    v_mov_b32 v16, s49
    v_mul_u32_u24 v9, 3641344, v1
    buffer_store_dword v16, v9, s[40:43], 0 offen sc1
    s_nop 0
L_fin:
L_done:
    s_endpgm
L_service:
    s_load_dwordx16 s[8:23], s[0:1], 0
    s_load_dwordx8 s[24:31], s[0:1], 64
    s_xor_b32 s3, s3, 4
    v_and_b32 v1, 63, v0
    v_mov_b32 v10, 8448
    v_mov_b32 v16, 0
    s_lshr_b32 s5, s2, 3
    s_and_b32 s4, s5, 7
    s_and_b32 s5, s5, 24
    s_and_b32 s51, s2, 7
    s_or_b32 s5, s5, s51
    v_lshrrev_b32 v12, 4, v1
    v_and_b32 v13, 15, v1
    v_lshlrev_b32 v14, 4, v1
    s_mov_b32 s58, 1048576
    s_setprio 2
    v_lshlrev_b32 v9, 2, v1
    ds_write_b32 v9, v16 offset:8448
    s_lshl_b32 s50, s3, 11
    s_waitcnt lgkmcnt(0)
    v_mov_b32 v11, 1
    v_mov_b32 v59, 0
    s_cmp_ge_u32 s2, 120
    s_nop 0
    s_cbranch_scc1 L_nox
    s_mov_b32 s44, s8
    s_and_b32 s45, s9, 0xffff
    s_mov_b32 s46, 0x2000
    s_mov_b32 s47, 0x20000
    buffer_load_dwordx4 v[20:23], v14, s[44:47], s50 offen
    buffer_load_dwordx4 v[24:27], v14, s[44:47], s50 offen offset:1024
    s_cmp_lt_u32 s2, 64
    s_cbranch_scc1 L_nob0
L_nox:
    s_barrier
L_nob0:
    s_load_dword s48, s[30:31], 0
    s_mov_b32 s77, 3641344
    s_load_dword s76, s[30:31], s77
    s_mov_b32 s40, s30
    s_and_b32 s41, s31, 0xffff
    s_mov_b32 s42, 0x379100
    s_mov_b32 s43, 0x20000
    s_cmp_ge_u32 s2, 120
    s_cbranch_scc1 L_nojob
    s_mov_b32 s35, 0x20000
    s_cmp_ge_u32 s2, 64
    s_cbranch_scc1 L_role1
    s_mov_b32 s32, s14
    s_and_b32 s33, s15, 0xffff
    s_mov_b32 s34, 4194304
    s_lshr_b32 s50, s2, 3
    s_add_u32 s50, s50, 4
    s_and_b32 s50, s50, 7
    s_and_b32 s51, s2, 7
    s_lshl_b32 s63, s51, 3
    s_add_u32 s63, s63, s50
    s_lshl_b32 s61, s50, 3
    s_add_u32 s61, s61, s51
    s_lshl_b32 s61, s61, 8
    s_add_u32 s61, s61, 4096
    s_lshl_b32 s52, s63, 7
    s_movk_i32 s53, 8192
    s_lshl_b32 s51, s63, 10
    s_add_u32 s51, s51, 3145728
    s_branch L_dma
L_role1:
    s_sub_u32 s63, s2, 64
    s_lshl_b32 s51, s63, 10
    s_add_u32 s51, s51, 3407872
    s_cmp_ge_u32 s63, 28
    s_cselect_b32 s32, s22, s20
    s_cselect_b32 s33, s23, s21
    s_cselect_b32 s50, 28, 0
    s_and_b32 s33, s33, 0xffff
    s_mov_b32 s34, 1835008
    s_sub_u32 s63, s63, s50
    s_lshl_b32 s52, s63, 7
    s_movk_i32 s53, 3584
    s_lshl_b32 s61, s2, 8
    s_add_u32 s61, s61, 4096
L_dma:
    v_lshrrev_b32 v9, 3, v1
    v_and_b32 v15, 7, v1
    v_and_b32 v17, 2, v9
    v_xor_b32 v15, v15, v17
    v_lshlrev_b32 v15, 4, v15
    v_mad_u32_u24 v15, v9, s53, v15
    v_xor_b32 v19, 64, v15
    s_lshl_b32 s50, s3, 7
    s_mul_i32 s50, s50, s53
    s_add_u32 s52, s52, s50
    s_lshl_b32 s53, s53, 3
    s_lshl_b32 s54, s3, 14
    s_add_u32 s54, s54, 16384
    s_mov_b32 m0, s54
    s_nop 0
    buffer_load_dwordx4 v15, s[32:35], s52 offen nt lds
    s_add_u32 m0, m0, 1024
    s_add_u32 s52, s52, s53
    buffer_load_dwordx4 v19, s[32:35], s52 offen nt lds
    s_add_u32 m0, m0, 1024
    s_add_u32 s52, s52, s53
    buffer_load_dwordx4 v15, s[32:35], s52 offen nt lds
    s_add_u32 m0, m0, 1024
    s_add_u32 s52, s52, s53
    buffer_load_dwordx4 v19, s[32:35], s52 offen nt lds
    s_add_u32 m0, m0, 1024
    s_add_u32 s52, s52, s53
    buffer_load_dwordx4 v15, s[32:35], s52 offen nt lds
    s_add_u32 m0, m0, 1024
    s_add_u32 s52, s52, s53
    buffer_load_dwordx4 v19, s[32:35], s52 offen nt lds
    s_add_u32 m0, m0, 1024
    s_add_u32 s52, s52, s53
    buffer_load_dwordx4 v15, s[32:35], s52 offen nt lds
    s_add_u32 m0, m0, 1024
    s_add_u32 s52, s52, s53
    buffer_load_dwordx4 v19, s[32:35], s52 offen nt lds
    s_add_u32 m0, m0, 1024
    s_add_u32 s52, s52, s53
    buffer_load_dwordx4 v15, s[32:35], s52 offen nt lds
    s_add_u32 m0, m0, 1024
    s_add_u32 s52, s52, s53
    buffer_load_dwordx4 v19, s[32:35], s52 offen nt lds
    s_add_u32 m0, m0, 1024
    s_add_u32 s52, s52, s53
    buffer_load_dwordx4 v15, s[32:35], s52 offen nt lds
    s_add_u32 m0, m0, 1024
    s_add_u32 s52, s52, s53
    buffer_load_dwordx4 v19, s[32:35], s52 offen nt lds
    s_add_u32 m0, m0, 1024
    s_add_u32 s52, s52, s53
    buffer_load_dwordx4 v15, s[32:35], s52 offen nt lds
    s_add_u32 m0, m0, 1024
    s_add_u32 s52, s52, s53
    buffer_load_dwordx4 v19, s[32:35], s52 offen nt lds
    s_add_u32 m0, m0, 1024
    s_add_u32 s52, s52, s53
    buffer_load_dwordx4 v15, s[32:35], s52 offen nt lds
    s_add_u32 m0, m0, 1024
    s_add_u32 s52, s52, s53
    buffer_load_dwordx4 v19, s[32:35], s52 offen nt lds
    s_cmp_ge_u32 s2, 64
    s_cbranch_scc1 L_nob1
    s_barrier
L_nob1:
    s_lshl_b32 s50, s3, 8
    s_add_u32 s51, s51, s50
    s_waitcnt vmcnt(16)
    s_mov_b32 s50, 0xffff0000
    v_lshlrev_b32 v48, 16, v20
    v_and_b32 v49, s50, v20
    v_lshlrev_b32 v50, 16, v21
    v_and_b32 v51, s50, v21
    v_lshlrev_b32 v52, 16, v22
    v_and_b32 v53, s50, v22
    v_lshlrev_b32 v54, 16, v23
    v_and_b32 v55, s50, v23
    v_lshlrev_b32 v56, 16, v24
    v_and_b32 v57, s50, v24
    v_lshlrev_b32 v58, 16, v25
    v_and_b32 v59, s50, v25
    v_lshlrev_b32 v60, 16, v26
    v_and_b32 v61, s50, v26
    v_lshlrev_b32 v62, 16, v27
    v_and_b32 v63, s50, v27
    v_add_f32 v40, v48, v49
    v_add_f32 v42, v50, v51
    v_add_f32 v40, v40, v52
    v_add_f32 v42, v42, v53
    v_add_f32 v40, v40, v54
    v_add_f32 v42, v42, v55
    v_add_f32 v40, v40, v42
    v_add_f32 v41, v56, v57
    v_add_f32 v43, v58, v59
    v_add_f32 v41, v41, v60
    v_add_f32 v43, v43, v61
    v_add_f32 v41, v41, v62
    v_add_f32 v43, v43, v63
    v_add_f32 v41, v41, v43
    v_add_f32_dpp v40, v40, v40 quad_perm:[1,0,3,2] row_mask:0xf bank_mask:0xf
    s_nop 0
    v_add_f32_dpp v41, v41, v41 quad_perm:[1,0,3,2] row_mask:0xf bank_mask:0xf
    v_add_f32_dpp v40, v40, v40 quad_perm:[2,3,0,1] row_mask:0xf bank_mask:0xf
    s_nop 0
    v_add_f32_dpp v41, v41, v41 quad_perm:[2,3,0,1] row_mask:0xf bank_mask:0xf
    v_add_f32_dpp v40, v40, v40 row_half_mirror row_mask:0xf bank_mask:0xf
    s_nop 0
    v_add_f32_dpp v41, v41, v41 row_half_mirror row_mask:0xf bank_mask:0xf
    v_add_f32_dpp v40, v40, v40 row_mirror row_mask:0xf bank_mask:0xf
    s_nop 0
    v_add_f32_dpp v41, v41, v41 row_mirror row_mask:0xf bank_mask:0xf
    v_mov_b32 v42, v40
    v_mov_b32 v43, v41
    s_nop 0
    v_permlane16_swap_b32 v40, v42
    v_permlane16_swap_b32 v41, v43
    v_add_f32 v40, v40, v42
    v_add_f32 v41, v41, v43
    v_mov_b32 v42, v40
    v_mov_b32 v43, v41
    s_nop 0
    v_permlane32_swap_b32 v40, v42
    v_permlane32_swap_b32 v41, v43
    v_add_f32 v40, v40, v42
    v_add_f32 v41, v41, v43
    v_mul_f32 v40, 0x3b000000, v40
    v_mul_f32 v41, 0x3b000000, v41
    v_sub_f32 v42, v48, v40
    v_sub_f32 v43, v56, v41
    v_mul_f32 v44, v42, v42
    v_mul_f32 v45, v43, v43
    v_sub_f32 v42, v49, v40
    v_sub_f32 v43, v57, v41
    v_fmac_f32 v44, v42, v42
    v_fmac_f32 v45, v43, v43
    v_sub_f32 v42, v50, v40
    v_sub_f32 v43, v58, v41
    v_fmac_f32 v44, v42, v42
    v_fmac_f32 v45, v43, v43
    v_sub_f32 v42, v51, v40
    v_sub_f32 v43, v59, v41
    v_fmac_f32 v44, v42, v42
    v_fmac_f32 v45, v43, v43
    v_sub_f32 v42, v52, v40
    v_sub_f32 v43, v60, v41
    v_fmac_f32 v44, v42, v42
    v_fmac_f32 v45, v43, v43
    v_sub_f32 v42, v53, v40
    v_sub_f32 v43, v61, v41
    v_fmac_f32 v44, v42, v42
    v_fmac_f32 v45, v43, v43
    v_sub_f32 v42, v54, v40
    v_sub_f32 v43, v62, v41
    v_fmac_f32 v44, v42, v42
    v_fmac_f32 v45, v43, v43
    v_sub_f32 v42, v55, v40
    v_sub_f32 v43, v63, v41
    v_fmac_f32 v44, v42, v42
    v_fmac_f32 v45, v43, v43
    s_nop 0
    v_add_f32_dpp v44, v44, v44 quad_perm:[1,0,3,2] row_mask:0xf bank_mask:0xf
    v_add_f32_dpp v45, v45, v45 quad_perm:[1,0,3,2] row_mask:0xf bank_mask:0xf
    s_nop 0
    v_add_f32_dpp v44, v44, v44 quad_perm:[2,3,0,1] row_mask:0xf bank_mask:0xf
    v_add_f32_dpp v45, v45, v45 quad_perm:[2,3,0,1] row_mask:0xf bank_mask:0xf
    s_nop 0
    v_add_f32_dpp v44, v44, v44 row_half_mirror row_mask:0xf bank_mask:0xf
    v_add_f32_dpp v45, v45, v45 row_half_mirror row_mask:0xf bank_mask:0xf
    s_nop 0
    v_add_f32_dpp v44, v44, v44 row_mirror row_mask:0xf bank_mask:0xf
    v_add_f32_dpp v45, v45, v45 row_mirror row_mask:0xf bank_mask:0xf
    v_mov_b32 v42, v44
    v_mov_b32 v43, v45
    s_nop 0
    v_permlane16_swap_b32 v44, v42
    v_permlane16_swap_b32 v45, v43
    v_add_f32 v44, v44, v42
    v_add_f32 v45, v45, v43
    v_mov_b32 v42, v44
    v_mov_b32 v43, v45
    s_nop 0
    v_permlane32_swap_b32 v44, v42
    v_permlane32_swap_b32 v45, v43
    v_add_f32 v44, v44, v42
    v_add_f32 v45, v45, v43
    v_mul_f32 v44, 0x3b000000, v44
    v_mul_f32 v45, 0x3b000000, v45
    v_cvt_pk_bf16_f32 v42, v40, v41
    v_lshlrev_b32 v40, 16, v42
    v_and_b32 v41, s50, v42
    v_cvt_pk_bf16_f32 v43, v44, v45
    v_lshlrev_b32 v44, 16, v43
    v_and_b32 v45, s50, v43
    v_add_f32 v44, 0x3727c5ac, v44
    v_add_f32 v45, 0x3727c5ac, v45
    v_cvt_pk_bf16_f32 v43, v44, v45
    v_lshlrev_b32 v44, 16, v43
    v_and_b32 v45, s50, v43
    v_sqrt_f32 v44, v44
    v_sqrt_f32 v45, v45
    s_nop 0
    v_cvt_pk_bf16_f32 v43, v44, v45
    v_lshlrev_b32 v44, 16, v43
    v_and_b32 v45, s50, v43
    v_rcp_f32 v44, v44
    v_rcp_f32 v45, v45
    v_sub_f32 v48, v48, v40
    v_sub_f32 v49, v49, v40
    v_sub_f32 v50, v50, v40
    v_sub_f32 v51, v51, v40
    v_sub_f32 v52, v52, v40
    v_sub_f32 v53, v53, v40
    v_sub_f32 v54, v54, v40
    v_sub_f32 v55, v55, v40
    v_cvt_pk_bf16_f32 v42, v48, v49
    v_lshlrev_b32 v48, 16, v42
    v_and_b32 v49, s50, v42
    v_cvt_pk_bf16_f32 v42, v50, v51
    v_lshlrev_b32 v50, 16, v42
    v_and_b32 v51, s50, v42
    v_cvt_pk_bf16_f32 v42, v52, v53
    v_lshlrev_b32 v52, 16, v42
    v_and_b32 v53, s50, v42
    v_cvt_pk_bf16_f32 v42, v54, v55
    v_lshlrev_b32 v54, 16, v42
    v_and_b32 v55, s50, v42
    v_mul_f32 v48, v48, v44
    v_mul_f32 v49, v49, v44
    v_mul_f32 v50, v50, v44
    v_mul_f32 v51, v51, v44
    v_mul_f32 v52, v52, v44
    v_mul_f32 v53, v53, v44
    v_mul_f32 v54, v54, v44
    v_mul_f32 v55, v55, v44
    v_cvt_pk_bf16_f32 v20, v48, v49
    v_cvt_pk_bf16_f32 v21, v50, v51
    v_cvt_pk_bf16_f32 v22, v52, v53
    v_cvt_pk_bf16_f32 v23, v54, v55
    v_sub_f32 v56, v56, v41
    v_sub_f32 v57, v57, v41
    v_sub_f32 v58, v58, v41
    v_sub_f32 v59, v59, v41
    v_sub_f32 v60, v60, v41
    v_sub_f32 v61, v61, v41
    v_sub_f32 v62, v62, v41
    v_sub_f32 v63, v63, v41
    v_cvt_pk_bf16_f32 v42, v56, v57
    v_lshlrev_b32 v56, 16, v42
    v_and_b32 v57, s50, v42
    v_cvt_pk_bf16_f32 v42, v58, v59
    v_lshlrev_b32 v58, 16, v42
    v_and_b32 v59, s50, v42
    v_cvt_pk_bf16_f32 v42, v60, v61
    v_lshlrev_b32 v60, 16, v42
    v_and_b32 v61, s50, v42
    v_cvt_pk_bf16_f32 v42, v62, v63
    v_lshlrev_b32 v62, 16, v42
    v_and_b32 v63, s50, v42
    v_mul_f32 v56, v56, v45
    v_mul_f32 v57, v57, v45
    v_mul_f32 v58, v58, v45
    v_mul_f32 v59, v59, v45
    v_mul_f32 v60, v60, v45
    v_mul_f32 v61, v61, v45
    v_mul_f32 v62, v62, v45
    v_mul_f32 v63, v63, v45
    v_cvt_pk_bf16_f32 v24, v56, v57
    v_cvt_pk_bf16_f32 v25, v58, v59
    v_cvt_pk_bf16_f32 v26, v60, v61
    v_cvt_pk_bf16_f32 v27, v62, v63
    s_mul_i32 s50, s3, 2080
    v_add_u32 v9, s50, v14
    ds_write_b128 v9, v[20:23] offset:0
    ds_write_b128 v9, v[24:27] offset:1040
    v_and_b32 v17, 7, v13
    v_mul_u32_u24 v9, 1040, v17
    v_lshl_add_u32 v9, v12, 4, v9
    v_lshlrev_b32 v59, 5, v17
    v_lshl_add_u32 v59, v12, 3, v59
    v_lshrrev_b32 v18, 2, v13
    v_lshl_add_u32 v18, v12, 3, v18
    v_lshlrev_b32 v18, 7, v18
    v_and_b32 v17, 3, v13
    v_lshl_add_u32 v18, v17, 3, v18
    v_bfe_u32 v17, v1, 3, 2
    v_xor_b32 v17, s3, v17
    v_lshl_add_u32 v18, v17, 5, v18
    v_add_u32 v18, 16384, v18
    s_waitcnt vmcnt(0) lgkmcnt(0)
    s_mov_b64 exec, 1
    ds_add_u32 v10, v11 offset:0
    s_mov_b64 exec, -1
    s_mul_i32 s49, s76, 0x9e3779b1
    s_mul_i32 s77, s48, 0x85ebca6c
    s_add_u32 s49, s49, s77
    s_add_u32 s49, s49, 0x7f4a7c15
    s_andn2_b32 s77, 2, s48
    s_andn2_b32 s49, s49, 2
    s_or_b32 s49, s49, s77
L_xn_wait:
    ds_read_b32 v16, v10 offset:0
    s_waitcnt lgkmcnt(0)
    v_readfirstlane_b32 s50, v16
    s_nop 0
    s_cmp_lt_u32 s50, 4
    s_nop 2
    s_cbranch_scc1 L_xn_wait
    ds_read_b128 v[128:131], v9 offset:0
    ds_read_b64_tr_b16 v[64:65], v18 offset:0
    ds_read_b64_tr_b16 v[66:67], v18 offset:512
    ds_read_b128 v[132:135], v9 offset:64
    ds_read_b64_tr_b16 v[68:69], v18 offset:4096
    ds_read_b64_tr_b16 v[70:71], v18 offset:4608
    ds_read_b128 v[136:139], v9 offset:128
    ds_read_b64_tr_b16 v[72:73], v18 offset:8192
    ds_read_b64_tr_b16 v[74:75], v18 offset:8704
    ds_read_b128 v[140:143], v9 offset:192
    ds_read_b64_tr_b16 v[76:77], v18 offset:12288
    ds_read_b64_tr_b16 v[78:79], v18 offset:12800
    ds_read_b128 v[144:147], v9 offset:256
    ds_read_b64_tr_b16 v[80:81], v18 offset:16384
    ds_read_b64_tr_b16 v[82:83], v18 offset:16896
    s_waitcnt lgkmcnt(12)
    v_mfma_f32_16x16x32_bf16 v[40:43], v[64:67], v[128:131], 0
    ds_read_b128 v[148:151], v9 offset:320
    ds_read_b64_tr_b16 v[84:85], v18 offset:20480
    ds_read_b64_tr_b16 v[86:87], v18 offset:20992
    s_waitcnt lgkmcnt(12)
    v_mfma_f32_16x16x32_bf16 v[40:43], v[68:71], v[132:135], v[40:43]
    ds_read_b128 v[152:155], v9 offset:384
    ds_read_b64_tr_b16 v[88:89], v18 offset:24576
    ds_read_b64_tr_b16 v[90:91], v18 offset:25088
    s_waitcnt lgkmcnt(12)
    v_mfma_f32_16x16x32_bf16 v[40:43], v[72:75], v[136:139], v[40:43]
    ds_read_b128 v[156:159], v9 offset:448
    ds_read_b64_tr_b16 v[92:93], v18 offset:28672
    ds_read_b64_tr_b16 v[94:95], v18 offset:29184
    s_waitcnt lgkmcnt(12)
    v_mfma_f32_16x16x32_bf16 v[40:43], v[76:79], v[140:143], v[40:43]
    ds_read_b128 v[160:163], v9 offset:512
    ds_read_b64_tr_b16 v[96:97], v18 offset:32768
    ds_read_b64_tr_b16 v[98:99], v18 offset:33280
    s_waitcnt lgkmcnt(12)
    v_mfma_f32_16x16x32_bf16 v[40:43], v[80:83], v[144:147], v[40:43]
    ds_read_b128 v[164:167], v9 offset:576
    ds_read_b64_tr_b16 v[100:101], v18 offset:36864
    ds_read_b64_tr_b16 v[102:103], v18 offset:37376
    s_waitcnt lgkmcnt(12)
    v_mfma_f32_16x16x32_bf16 v[40:43], v[84:87], v[148:151], v[40:43]
    ds_read_b128 v[168:171], v9 offset:640
    ds_read_b64_tr_b16 v[104:105], v18 offset:40960
    ds_read_b64_tr_b16 v[106:107], v18 offset:41472
    s_waitcnt lgkmcnt(12)
    v_mfma_f32_16x16x32_bf16 v[40:43], v[88:91], v[152:155], v[40:43]
    ds_read_b128 v[172:175], v9 offset:704
    ds_read_b64_tr_b16 v[108:109], v18 offset:45056
    ds_read_b64_tr_b16 v[110:111], v18 offset:45568
    s_waitcnt lgkmcnt(12)
    v_mfma_f32_16x16x32_bf16 v[40:43], v[92:95], v[156:159], v[40:43]
    ds_read_b128 v[176:179], v9 offset:768
    ds_read_b64_tr_b16 v[112:113], v18 offset:49152
    ds_read_b64_tr_b16 v[114:115], v18 offset:49664
    s_waitcnt lgkmcnt(12)
    v_mfma_f32_16x16x32_bf16 v[40:43], v[96:99], v[160:163], v[40:43]
    ds_read_b128 v[180:183], v9 offset:832
    ds_read_b64_tr_b16 v[116:117], v18 offset:53248
    ds_read_b64_tr_b16 v[118:119], v18 offset:53760
    s_waitcnt lgkmcnt(12)
    v_mfma_f32_16x16x32_bf16 v[40:43], v[100:103], v[164:167], v[40:43]
    ds_read_b128 v[184:187], v9 offset:896
    ds_read_b64_tr_b16 v[120:121], v18 offset:57344
    ds_read_b64_tr_b16 v[122:123], v18 offset:57856
    s_waitcnt lgkmcnt(12)
    v_mfma_f32_16x16x32_bf16 v[40:43], v[104:107], v[168:171], v[40:43]
    ds_read_b128 v[188:191], v9 offset:960
    ds_read_b64_tr_b16 v[124:125], v18 offset:61440
    ds_read_b64_tr_b16 v[126:127], v18 offset:61952
    s_waitcnt lgkmcnt(12)
    v_mfma_f32_16x16x32_bf16 v[40:43], v[108:111], v[172:175], v[40:43]
    s_waitcnt lgkmcnt(9)
    v_mfma_f32_16x16x32_bf16 v[40:43], v[112:115], v[176:179], v[40:43]
    s_waitcnt lgkmcnt(6)
    v_mfma_f32_16x16x32_bf16 v[40:43], v[116:119], v[180:183], v[40:43]
    s_waitcnt lgkmcnt(3)
    v_mfma_f32_16x16x32_bf16 v[40:43], v[120:123], v[184:187], v[40:43]
    s_waitcnt lgkmcnt(0)
    v_mfma_f32_16x16x32_bf16 v[40:43], v[124:127], v[188:191], v[40:43]
    s_nop 7
    v_cvt_pk_bf16_f32 v60, v40, v41
    v_cvt_pk_bf16_f32 v61, v42, v43
    s_mov_b32 exec_lo, 0x00ff00ff
    s_mov_b32 exec_hi, 0x00ff00ff
    buffer_store_dwordx2 v[60:61], v59, s[40:43], s51 offen sc1
    s_mov_b64 exec, 1
    s_waitcnt vmcnt(0)
    ds_add_rtn_u32 v17, v10, v11
    s_mov_b64 exec, 0xff
    v_mov_b32 v60, 0
    v_mov_b32 v61, s49
    v_mov_b32 v62, 0
    v_mov_b32 v63, 0
    s_waitcnt lgkmcnt(0)
    v_readfirstlane_b32 s50, v17
    s_nop 0
    s_cmp_eq_u32 s50, 7
    s_cselect_b32 s61, s61, 0x7fffff00
    buffer_store_dwordx4 v[60:63], v14, s[40:43], s61 offen sc1
    s_mov_b64 exec, -1
    s_nop 0
L_nojob:
    s_waitcnt lgkmcnt(0)
    s_mul_i32 s49, s76, 0x9e3779b1
    s_mul_i32 s77, s48, 0x85ebca6c
    s_add_u32 s49, s49, s77
    s_add_u32 s49, s49, 0x7f4a7c15
    s_andn2_b32 s77, 2, s48
    s_andn2_b32 s49, s49, 2
    s_or_b32 s49, s49, s77
    s_and_b32 s59, s49, 0xffff
    s_cmp_lg_u32 s3, 0
    s_cbranch_scc1 L_svc_bq
    s_and_b32 s52, s6, 7
    s_lshl_b32 s51, s52, 13
    s_lshr_b32 s50, s6, 3
    s_lshl_b32 s50, s50, 5
    s_add_u32 s51, s51, s50
    s_add_u32 s51, s51, 3145728
    s_lshl_b32 s52, s52, 8
    s_add_u32 s52, s52, 4100
    v_lshrrev_b32 v9, 1, v1
    v_lshlrev_b32 v9, 8, v9
    v_and_b32 v17, 1, v1
    v_lshl_add_u32 v9, v17, 4, v9
    v_and_b32 v18, 7, v1
    v_lshlrev_b32 v18, 11, v18
    s_nop 1
L_q_trig:
    s_sleep 4
    ds_read_b32 v16, v10 offset:8
    s_waitcnt lgkmcnt(0)
    v_readfirstlane_b32 s50, v16
    s_nop 0
    s_cmp_lt_u32 s50, 1
    s_nop 2
    s_cbranch_scc1 L_q_trig
L_q_poll:
    buffer_load_dword v20, v18, s[40:43], s52 offen sc1
    s_addk_i32 s58, -1
    s_cmp_lt_i32 s58, 0
    s_cbranch_scc1 L_q_ok
    s_waitcnt vmcnt(0)
    v_cmp_ne_u32 vcc, s49, v20
    s_nop 4
    s_cbranch_vccz L_q_ok
    s_sleep 8
    s_branch L_q_poll
L_q_ok:
    buffer_load_dwordx4 v[24:27], v9, s[40:43], s51 offen sc1
    s_waitcnt vmcnt(0)
    ds_write_b128 v14, v[24:27] offset:8704
    s_waitcnt lgkmcnt(0)
L_svc_bq:
    s_barrier
    s_setprio 0
L_w_wait:
    s_sleep 32
    ds_read_b32 v16, v10 offset:4
    s_waitcnt lgkmcnt(0)
    v_readfirstlane_b32 s50, v16
    s_nop 0
    s_cmp_lt_u32 s50, 4
    s_nop 2
    s_cbranch_scc1 L_w_wait
    v_lshlrev_b32 v9, 2, v1
    v_and_b32 v18, 1, v1
    v_mul_u32_u24 v18, 7168, v18
    v_lshrrev_b32 v17, 3, v1
    v_mul_u32_u24 v47, 144, v17
    v_and_b32 v17, 7, v1
    v_lshl_add_u32 v47, v17, 2, v47
    s_lshl_b32 s50, s3, 5
    v_add_u32 v47, s50, v47
    s_lshl_b32 s51, s5, 2
    s_add_u32 s51, s51, s3
    s_lshl_b32 s51, s51, 8
    s_add_u32 s51, s51, 3407872
    s_add_u32 s52, s51, 28672
    s_lshl_b32 s61, s5, 8
    s_add_u32 s61, s61, 20484
    v_mov_b32 v16, 0
    s_cmp_ge_u32 s5, 28
    s_nop 0
    s_cbranch_scc1 L_gu_none
L_gu_poll:
    buffer_load_dword v20, v18, s[40:43], s61 offen sc1
    s_addk_i32 s58, -1
    s_cmp_lt_i32 s58, 0
    s_cbranch_scc1 L_gu_ok
    s_waitcnt vmcnt(0)
    v_cmp_ne_u32 vcc, s49, v20
    s_nop 4
    s_cbranch_vccz L_gu_ok
    s_sleep 32
    s_branch L_gu_poll
L_gu_ok:
    buffer_load_dword v20, v9, s[40:43], s51 offen sc1
    buffer_load_dword v22, v9, s[40:43], s52 offen sc1
    s_waitcnt vmcnt(0)
    v_lshlrev_b32 v21, 16, v20
    v_and_b32 v20, 0xffff0000, v20
    v_lshlrev_b32 v23, 16, v22
    v_and_b32 v22, 0xffff0000, v22
    v_mul_f32 v21, v21, v23
    v_mul_f32 v20, v20, v22
    v_cvt_pk_bf16_f32 v16, v21, v20
    s_nop 1
L_gu_none:
    ds_write_b32 v47, v16 offset:12288
    s_waitcnt lgkmcnt(0)
    s_mov_b64 exec, 1
    ds_add_u32 v10, v11 offset:12
    s_mov_b64 exec, -1
    v_and_b32 v17, 7, v13
    v_mul_u32_u24 v9, 144, v17
    v_lshl_add_u32 v9, v12, 4, v9
    s_nop 1
L_h_wait:
    s_sleep 2
    ds_read_b32 v16, v10 offset:12
    s_waitcnt lgkmcnt(0)
    v_readfirstlane_b32 s50, v16
    s_nop 0
    s_cmp_lt_u32 s50, 4
    s_nop 2
    s_cbranch_scc1 L_h_wait
    ds_read_b128 v[88:91], v9 offset:12288
    ds_read_b128 v[92:95], v9 offset:12352
    s_lshl_b32 s50, s3, 5
    s_add_u32 s50, s50, 9728
    v_mov_b32 v45, s50
    v_lshlrev_b32 v44, 3, v1
    s_lshl_b32 s50, s3, 9
    v_add_u32 v44, s50, v44
    s_and_b32 s51, s6, 7
    s_lshl_b32 s51, s51, 2
    s_add_u32 s51, s51, s3
    s_lshl_b32 s51, s51, 5
    s_lshr_b32 s50, s6, 3
    s_lshl_b32 s50, s50, 2
    s_add_u32 s51, s51, s50
    s_add_u32 s51, s51, s7
    s_lshl_b32 s51, s51, 9
    s_add_u32 s51, s51, 1048576
    s_mov_b32 s53, 0x3fb8aa3b
    v_lshlrev_b32 v46, 3, v1
    v_bfe_u32 v11, v13, 1, 2
    v_lshlrev_b32 v47, 12, v11
    v_lshl_add_u32 v47, v12, 4, v47
    v_and_b32 v11, 1, v13
    v_lshl_add_u32 v47, v11, 6, v47
    s_lshl_b32 s65, s4, 16
    s_lshl_b32 s50, s3, 14
    s_add_u32 s65, s65, s50
    s_lshl_b32 s50, s5, 7
    s_add_u32 s65, s65, s50
    s_add_u32 s65, s65, 2097152
    s_and_b32 s50, s49, 0xff
    v_mov_b32 v56, s50
    s_bfe_u32 s50, s49, 0x80008
    v_mov_b32 v57, s50
    s_mov_b32 s64, 0xffffff00
    s_mov_b32 s62, 0xaaaaaaaa
    s_mov_b32 s63, 0xaaaaaaaa
    buffer_load_dwordx4 v[52:55], v47, s[40:43], s65 offen sc1
    s_lshl_b32 s50, s5, 17
    s_add_u32 s32, s16, s50
    s_addc_u32 s33, s17, 0
    s_and_b32 s33, s33, 0xffff
    s_mov_b32 s34, 131072
    s_mov_b32 s35, 0x20000
    s_mov_b32 s36, s24
    s_and_b32 s37, s25, 0xffff
    s_mov_b32 s38, 0x1c0000
    s_mov_b32 s39, 0x20000
    v_lshrrev_b32 v9, 3, v1
    v_and_b32 v15, 7, v1
    v_lshlrev_b32 v15, 4, v15
    v_lshl_add_u32 v15, v9, 10, v15
    s_lshl_b32 s60, s3, 15
    s_lshl_b32 s50, s4, 7
    s_add_u32 s60, s60, s50
    s_lshl_b32 s61, s3, 14
    s_add_u32 s61, s61, s50
    s_lshl_b32 s50, s5, 16
    s_add_u32 s61, s61, s50
    s_lshl_b32 s54, s3, 12
    s_add_u32 s54, s54, 49152
    s_lshl_b32 s55, s3, 11
    s_add_u32 s55, s55, 65536
    v_lshrrev_b32 v9, 2, v13
    v_lshl_add_u32 v9, v12, 3, v9
    v_lshlrev_b32 v9, 7, v9
    v_and_b32 v17, 3, v13
    v_lshl_add_u32 v9, v17, 3, v9
    s_lshl_b32 s50, s3, 5
    s_add_u32 s50, s50, 49152
    v_add_u32 v48, s50, v9
    v_and_b32 v17, 7, v13
    v_mul_u32_u24 v49, 272, v17
    v_lshl_add_u32 v49, v12, 4, v49
    v_mov_b32 v11, 1
    s_nop 1
L_dyn_w:
    s_sleep 16
    ds_read_b32 v16, v10 offset:32
    s_waitcnt lgkmcnt(0)
    v_readfirstlane_b32 s50, v16
    s_nop 0
    s_cmp_lt_u32 s50, 1
    s_nop 2
    s_cbranch_scc1 L_dyn_w
L_end_w:
    s_sleep 1
    ds_read_b32 v16, v10 offset:24
    s_waitcnt lgkmcnt(0)
    v_readfirstlane_b32 s50, v16
    s_nop 0
    s_cmp_lt_u32 s50, 1
    s_nop 2
    s_cbranch_scc1 L_end_w
    s_setprio 2
L_ml_w4:
    ds_read_b32 v16, v10 offset:16
    s_waitcnt lgkmcnt(0)
    v_readfirstlane_b32 s50, v16
    s_nop 0
    s_cmp_lt_u32 s50, 4
    s_nop 2
    s_cbranch_scc1 L_ml_w4
    ds_read_b128 v[24:27], v45
    ds_read_b128 v[28:31], v45 offset:16
    s_mov_b32 m0, s54
    s_nop 0
    buffer_load_dwordx4 v15, s[32:35], s60 offen nt lds
    s_add_u32 m0, m0, 1024
    s_add_u32 s60, s60, 8192
    buffer_load_dwordx4 v15, s[32:35], s60 offen nt lds
    s_add_u32 m0, m0, 1024
    s_add_u32 s60, s60, 8192
    buffer_load_dwordx4 v15, s[32:35], s60 offen nt lds
    s_add_u32 m0, m0, 1024
    s_add_u32 s60, s60, 8192
    buffer_load_dwordx4 v15, s[32:35], s60 offen nt lds
    s_mov_b32 m0, s55
    s_nop 0
    buffer_load_dwordx4 v15, s[36:39], s61 offen nt lds
    s_add_u32 m0, m0, 1024
    s_add_u32 s61, s61, 8192
    buffer_load_dwordx4 v15, s[36:39], s61 offen nt lds
    s_waitcnt lgkmcnt(0)
    v_max3_f32 v36, v24, v26, v28
    v_max_f32 v36, v36, v30
    v_sub_f32 v24, v24, v36
    v_sub_f32 v26, v26, v36
    v_sub_f32 v28, v28, v36
    v_sub_f32 v30, v30, v36
    v_mul_f32 v24, s53, v24
    v_mul_f32 v26, s53, v26
    v_mul_f32 v28, s53, v28
    v_mul_f32 v30, s53, v30
    v_exp_f32 v24, v24
    v_exp_f32 v26, v26
    v_exp_f32 v28, v28
    v_exp_f32 v30, v30
    s_barrier
    ds_read_b64 v[16:17], v44 offset:16384
    ds_read_b64 v[18:19], v44 offset:18432
    ds_read_b64 v[20:21], v44 offset:20480
    ds_read_b64 v[22:23], v44 offset:22528
    v_mul_f32 v38, v24, v25
    v_fmac_f32 v38, v26, v27
    v_fmac_f32 v38, v28, v29
    v_fmac_f32 v38, v30, v31
    v_log_f32 v37, v38
    v_rcp_f32 v38, v38
    v_fmac_f32 v37, s53, v36
    v_lshlrev_b32 v36, 16, v37
    v_cndmask_b32 v37, v37, v36, s[62:63]
    v_and_b32 v37, 0xffff0000, v37
    v_or_b32 v37, s59, v37
    s_waitcnt lgkmcnt(3)
    v_mul_f32 v32, v24, v16
    v_mul_f32 v34, v24, v17
    s_waitcnt lgkmcnt(2)
    v_fmac_f32 v32, v26, v18
    v_fmac_f32 v34, v26, v19
    s_waitcnt lgkmcnt(1)
    v_fmac_f32 v32, v28, v20
    v_fmac_f32 v34, v28, v21
    s_waitcnt lgkmcnt(0)
    v_fmac_f32 v32, v30, v22
    v_fmac_f32 v34, v30, v23
    v_mul_f32 v32, v32, v38
    v_mul_f32 v34, v34, v38
    v_cvt_pk_bf16_f32 v36, v32, v34
    buffer_store_dwordx2 v[36:37], v46, s[40:43], s51 offen sc1
    s_waitcnt vmcnt(1)
    s_mov_b64 exec, 1
    ds_add_u32 v10, v11 offset:20
    s_mov_b64 exec, -1
L_lw_wait:
    ds_read_b32 v16, v10 offset:20
    s_waitcnt lgkmcnt(0)
    v_readfirstlane_b32 s50, v16
    s_nop 0
    s_cmp_lt_u32 s50, 4
    s_nop 2
    s_cbranch_scc1 L_lw_wait
    ds_read_b64_tr_b16 v[80:81], v48 offset:16384
    ds_read_b64_tr_b16 v[82:83], v48 offset:16896
    ds_read_b64_tr_b16 v[84:85], v48 offset:20480
    ds_read_b64_tr_b16 v[86:87], v48 offset:20992
    ds_read_b64_tr_b16 v[64:65], v48 offset:0
    ds_read_b64_tr_b16 v[66:67], v48 offset:512
    ds_read_b64_tr_b16 v[68:69], v48 offset:4096
    ds_read_b64_tr_b16 v[70:71], v48 offset:4608
    ds_read_b64_tr_b16 v[72:73], v48 offset:8192
    ds_read_b64_tr_b16 v[74:75], v48 offset:8704
    ds_read_b64_tr_b16 v[76:77], v48 offset:12288
    ds_read_b64_tr_b16 v[78:79], v48 offset:12800
    s_waitcnt lgkmcnt(8)
    v_mfma_f32_16x16x32_bf16 v[40:43], v[80:83], v[88:91], 0
    v_mfma_f32_16x16x32_bf16 v[40:43], v[84:87], v[92:95], v[40:43]
    s_waitcnt lgkmcnt(0)
    s_barrier
    ds_read_b128 v[96:99], v49 offset:9856
    ds_read_b128 v[100:103], v49 offset:9920
    ds_read_b128 v[104:107], v49 offset:9984
    ds_read_b128 v[108:111], v49 offset:10048
    s_waitcnt lgkmcnt(3)
    v_mfma_f32_16x16x32_bf16 v[40:43], v[64:67], v[96:99], v[40:43]
    s_waitcnt lgkmcnt(2)
    v_mfma_f32_16x16x32_bf16 v[40:43], v[68:71], v[100:103], v[40:43]
    s_waitcnt lgkmcnt(1)
    v_mfma_f32_16x16x32_bf16 v[40:43], v[72:75], v[104:107], v[40:43]
    s_waitcnt lgkmcnt(0)
    v_mfma_f32_16x16x32_bf16 v[40:43], v[76:79], v[108:111], v[40:43]
    s_mov_b32 exec_lo, 0x00ff00ff
    s_mov_b32 exec_hi, 0x00ff00ff
    s_nop 5
    v_bfi_b32 v40, s64, v40, v56
    v_bfi_b32 v41, s64, v41, v57
    v_bfi_b32 v42, s64, v42, v56
    v_bfi_b32 v43, s64, v43, v57
    buffer_store_dwordx4 v[40:43], v47, s[40:43], s65 offen sc1
    s_waitcnt vmcnt(0)
    s_mov_b64 exec, 1
    ds_add_u32 v10, v11 offset:12
    s_mov_b64 exec, -1
    s_waitcnt lgkmcnt(0)
    s_endpgm
.section .rodata,"a"
.p2align 6
.amdhsa_kernel parallel_sum__gqa_block_cached__glu_gated_bilinear__decode_kernel
  .amdhsa_next_free_vgpr 256
  .amdhsa_next_free_sgpr 102
  .amdhsa_accum_offset 256
  .amdhsa_group_segment_fixed_size 0
  .amdhsa_kernarg_size 96
  .amdhsa_user_sgpr_count 2
  .amdhsa_user_sgpr_kernarg_segment_ptr 1
  .amdhsa_system_sgpr_workgroup_id_x 1
.end_amdhsa_kernel
```
